```python
import torch

def _softmax(x, axis=-1):
    return torch.softmax(x, dim=axis)
def _gelu(x):
    return torch.nn.functional.gelu(x, approximate="tanh")
def _silu(x):
    return torch.nn.functional.silu(x)
def _sigmoid(x):
    return torch.sigmoid(x)
def _layernorm(x, axis=-1, eps=1e-5):
    m = x.mean(dim=axis, keepdim=True)
    v = x.var(dim=axis, keepdim=True, unbiased=False)
    return (x - m) / torch.sqrt(v + eps)
def _scatter_add(tgt, idx, src, axis=0):
    return tgt.clone().index_add_(axis, idx, src)
def _segment_sum(src, seg, n):
    out = torch.zeros((n,) + src.shape[1:], dtype=src.dtype)
    return out.index_add_(0, seg, src)
def _pad(x, pw):
    flat = tuple(v for pair in reversed(pw) for v in pair)
    return torch.nn.functional.pad(x, flat)

kernel_name = 'recurrent_scan__softmax_full_mha__mixer_channel_mlp__prompt'

def setup_inputs():

    _w = (lambda a: (lambda t: t.to(torch.bfloat16) if t.is_floating_point() else t)(torch.as_tensor(a)))
    def _A_setup():
        B, S, D = 1, 2048, 512
        return {
            "x": _w((lambda *s: torch.randn(*s, dtype=torch.bfloat16) * 0.05)(B, S, D)),
            "wqkv": _w((lambda *s: torch.randn(*s, dtype=torch.bfloat16) * 0.1)(D, 3 * D)),
            "wo": _w((lambda *s: torch.randn(*s, dtype=torch.bfloat16) * 0.05)(D, D)),
        }
    _A_in = _A_setup()

    def _B_setup():
        B, S, D, F = 1, 2048, 512, 1792
        return {
            "x": _w((lambda *s: torch.randn(*s, dtype=torch.bfloat16) * 0.05)(B, S, D)),
            "w1": _w((lambda *s: torch.randn(*s, dtype=torch.bfloat16) * 3.2)(D, F) * (D ** -0.5)),
            "b1": _w((lambda *s: torch.randn(*s, dtype=torch.bfloat16) * 1.6)(F)),
            "w2": _w((lambda *s: torch.randn(*s, dtype=torch.bfloat16) * 0.8)(F, D) * (F ** -0.5)),
            "b2": _w((lambda *s: torch.randn(*s, dtype=torch.bfloat16) * 0.8)(D)),
        }
    _B_in = _B_setup()

    return {
        "A_x": _A_in["x"],
        "A_wqkv": _A_in["wqkv"],
        "A_wo": _A_in["wo"],
        "B_x": _B_in["x"],
        "B_w1": _B_in["w1"],
        "B_b1": _B_in["b1"],
        "B_w2": _B_in["w2"],
        "B_b2": _B_in["b2"],
    }

def reference(A_x, A_wqkv, A_wo, B_x, B_w1, B_b1, B_w2, B_b2):
    def _A_ref(x, wqkv, wo):
        B, S, D = x.shape
        H = 32; Dh = D // H
        qkv = (lambda x, *d: x.permute(*d))((x @ wqkv).reshape(B, S, 3, H, Dh), 2, 0, 3, 1, 4)
        q, k, v = qkv[0], qkv[1], qkv[2]
        scale = Dh ** -0.5
        scores = torch.einsum("bhqd,bhkd->bhqk", q, k) * scale
        p = _softmax(scores, axis=-1)
        o = torch.einsum("bhqk,bhkd->bhqd", p, v)
        return (lambda x, *d: x.permute(*d))(o, 0, 2, 1, 3).reshape(B, S, D) @ wo

    def _B_ref(x, w1, b1, w2, b2):
        y = _layernorm(x, axis=-1)
        h = _gelu(torch.einsum("bsd,df->bsf", y, w1) + b1)
        return torch.einsum("bsf,fd->bsd", h, w2) + b2

    x = A_x
    xn = _layernorm(x, axis=-1)
    s = _A_ref(xn, A_wqkv, A_wo)
    g = _silu(_B_ref(xn, B_w1, B_b1, B_w2, B_b2))
    return x + s * g
```

```asm
; @launch grid=(256,1,1) block=(768,1,1) lds=161920
.amdgcn_target "amdgcn-amd-amdhsa--gfx950"
.text
.globl recurrent_scan__softmax_full_mha__mixer_channel_mlp__prompt_kernel
.p2align 8
.type recurrent_scan__softmax_full_mha__mixer_channel_mlp__prompt_kernel,@function
recurrent_scan__softmax_full_mha__mixer_channel_mlp__prompt_kernel:
    s_cmp_ge_u32 s2, 256
    s_cbranch_scc1 FZ_END
    s_load_dwordx4 s[4:7], s[0:1], 0
    s_load_dwordx2 s[8:9], s[0:1], 16
    s_load_dwordx4 s[12:15], s[0:1], 32
    s_load_dwordx4 s[16:19], s[0:1], 48
    s_load_dwordx4 s[20:23], s[0:1], 64
    s_load_dwordx2 s[24:25], s[0:1], 80
    v_lshrrev_b32 v2, 6, v0
    v_and_b32 v1, 63, v0
    s_nop 0
    v_readfirstlane_b32 s48, v2
    v_lshlrev_b32 v2, 4, v1
    s_and_b32 s54, s2, 7
    s_lshr_b32 s55, s2, 3
    s_and_b32 s56, s54, 1
    s_lshl_b32 s56, s56, 3
    s_and_b32 s57, s55, 7
    s_add_u32 s50, s56, s57
    s_lshr_b32 s54, s54, 1
    s_lshl_b32 s54, s54, 2
    s_lshr_b32 s55, s55, 3
    s_add_u32 s51, s54, s55
    s_and_b32 s49, s48, 3
    s_mov_b32 s64, 0x3f803f80
    s_mov_b32 s92, 0xffff0000
    s_lshl_b32 s53, s50, 2
    s_add_u32 s53, s53, s49
    s_lshr_b32 s54, s51, 1
    s_mul_i32 s54, s54, 7
    s_and_b32 s55, s51, 1
    s_lshl_b32 s55, s55, 2
    s_add_u32 s52, s54, s55
    v_lshrrev_b32 v18, 4, v1
    v_and_b32 v18, 1, v18
    v_lshlrev_b32 v18, 5, v18
    v_and_b32 v19, 3, v1
    v_lshlrev_b32 v19, 3, v19
    v_add_u32 v18, v18, v19
    v_lshrrev_b32 v19, 2, v1
    v_and_b32 v19, 3, v19
    v_lshlrev_b32 v19, 6, v19
    v_add_u32 v18, v18, v19
    v_lshrrev_b32 v19, 5, v1
    s_cmp_ge_u32 s48, 8
    s_cbranch_scc1 PB_LD
    v_lshlrev_b32 v20, 9, v19
    v_add_u32 v7, v18, v20
    v_and_b32 v20, 31, v1
    v_lshrrev_b32 v21, 1, v20
    v_and_b32 v21, 7, v21
    v_xor_b32 v21, v21, v19
    v_lshlrev_b32 v21, 4, v21
    v_lshlrev_b32 v20, 7, v20
    v_add_u32 v21, v21, v20
    s_lshl_b32 s54, s49, 12
    v_add_u32 v3, s54, v21
    v_xor_b32 v4, 32, v3
    v_xor_b32 v5, 64, v3
    v_xor_b32 v6, 96, v3
    v_mov_b32 v12, 0
    v_mov_b32 v13, 0
    v_mov_b32 v14, 0
    v_mov_b32 v15, 0
    s_mov_b32 s26, 0
    s_mov_b32 s71, 0
    v_mov_b32 v16, 0
    v_mov_b32 v17, 0
    v_mov_b32 v18, 0
    v_mov_b32 v19, 0
    s_cmp_ge_u32 s48, 4
    s_cbranch_scc1 PB_HELP
PB_GEMM:
    v_mov_b32 v56, 0
    v_mov_b32 v57, 0
    v_mov_b32 v58, 0
    v_mov_b32 v59, 0
    v_mov_b32 v60, 0
    v_mov_b32 v61, 0
    v_mov_b32 v62, 0
    v_mov_b32 v63, 0
    v_mov_b32 v64, 0
    v_mov_b32 v65, 0
    v_mov_b32 v66, 0
    v_mov_b32 v67, 0
    v_mov_b32 v68, 0
    v_mov_b32 v69, 0
    v_mov_b32 v70, 0
    v_mov_b32 v71, 0
    v_mov_b32 v72, 0
    v_mov_b32 v73, 0
    v_mov_b32 v74, 0
    v_mov_b32 v75, 0
    v_mov_b32 v76, 0
    v_mov_b32 v77, 0
    v_mov_b32 v78, 0
    v_mov_b32 v79, 0
    v_mov_b32 v80, 0
    v_mov_b32 v81, 0
    v_mov_b32 v82, 0
    v_mov_b32 v83, 0
    v_mov_b32 v84, 0
    v_mov_b32 v85, 0
    v_mov_b32 v86, 0
    v_mov_b32 v87, 0
    v_mov_b32 v88, 0
    v_mov_b32 v89, 0
    v_mov_b32 v90, 0
    v_mov_b32 v91, 0
    v_mov_b32 v92, 0
    v_mov_b32 v93, 0
    v_mov_b32 v94, 0
    v_mov_b32 v95, 0
    v_mov_b32 v96, 0
    v_mov_b32 v97, 0
    v_mov_b32 v98, 0
    v_mov_b32 v99, 0
    v_mov_b32 v100, 0
    v_mov_b32 v101, 0
    v_mov_b32 v102, 0
    v_mov_b32 v103, 0
    v_mov_b32 v104, 0
    v_mov_b32 v105, 0
    v_mov_b32 v106, 0
    v_mov_b32 v107, 0
    v_mov_b32 v108, 0
    v_mov_b32 v109, 0
    v_mov_b32 v110, 0
    v_mov_b32 v111, 0
    v_mov_b32 v112, 0
    v_mov_b32 v113, 0
    v_mov_b32 v114, 0
    v_mov_b32 v115, 0
    v_mov_b32 v116, 0
    v_mov_b32 v117, 0
    v_mov_b32 v118, 0
    v_mov_b32 v119, 0
    v_mov_b32 v120, 0
    v_mov_b32 v121, 0
    v_mov_b32 v122, 0
    v_mov_b32 v123, 0
    v_mov_b32 v124, 0
    v_mov_b32 v125, 0
    v_mov_b32 v126, 0
    v_mov_b32 v127, 0
    v_mov_b32 v128, 0
    v_mov_b32 v129, 0
    v_mov_b32 v130, 0
    v_mov_b32 v131, 0
    v_mov_b32 v132, 0
    v_mov_b32 v133, 0
    v_mov_b32 v134, 0
    v_mov_b32 v135, 0
    v_mov_b32 v136, 0
    v_mov_b32 v137, 0
    v_mov_b32 v138, 0
    v_mov_b32 v139, 0
    v_mov_b32 v140, 0
    v_mov_b32 v141, 0
    v_mov_b32 v142, 0
    v_mov_b32 v143, 0
    v_mov_b32 v144, 0
    v_mov_b32 v145, 0
    v_mov_b32 v146, 0
    v_mov_b32 v147, 0
    v_mov_b32 v148, 0
    v_mov_b32 v149, 0
    v_mov_b32 v150, 0
    v_mov_b32 v151, 0
    v_mov_b32 v152, 0
    v_mov_b32 v153, 0
    v_mov_b32 v154, 0
    v_mov_b32 v155, 0
    v_mov_b32 v156, 0
    v_mov_b32 v157, 0
    v_mov_b32 v158, 0
    v_mov_b32 v159, 0
    v_mov_b32 v160, 0
    v_mov_b32 v161, 0
    v_mov_b32 v162, 0
    v_mov_b32 v163, 0
    v_mov_b32 v164, 0
    v_mov_b32 v165, 0
    v_mov_b32 v166, 0
    v_mov_b32 v167, 0
    v_mov_b32 v8, 0
    v_mov_b32 v9, 0
    v_mov_b32 v10, 0
    v_mov_b32 v11, 0
    v_mov_b32 v12, 0
    v_mov_b32 v13, 0
    v_mov_b32 v14, 0
    v_mov_b32 v15, 0
    v_and_b32 v20, 15, v1
    v_lshrrev_b32 v21, 4, v1
    v_and_b32 v21, 1, v21
    v_cmp_eq_u32 vcc, v20, v21
    v_mov_b32 v20, s64
    v_mov_b32 v21, 0
    v_cndmask_b32 v16, v21, v20, vcc
    v_mov_b32 v17, v16
    v_mov_b32 v18, v16
    v_mov_b32 v19, v16
    s_waitcnt lgkmcnt(0)
    s_mov_b32 s28, s24
    s_mov_b32 s29, s25
    s_mov_b32 s30, 25165824
    s_mov_b32 s31, 0x20000
    s_bitcmp1_b32 s51, 0
    s_cbranch_scc1 PB_G6
PB_G7:
    s_barrier
    ds_read_b128 v[20:23], v3
    ds_read_b64_tr_b16 v[28:29], v7 offset:16384
    ds_read_b64_tr_b16 v[30:31], v7 offset:16640
    ds_read_b64_tr_b16 v[32:33], v7 offset:20480
    ds_read_b64_tr_b16 v[34:35], v7 offset:20736
    ds_read_b64_tr_b16 v[36:37], v7 offset:24576
    ds_read_b64_tr_b16 v[38:39], v7 offset:24832
    ds_read_b64_tr_b16 v[40:41], v7 offset:28672
    ds_read_b64_tr_b16 v[42:43], v7 offset:28928
    ds_read_b64_tr_b16 v[44:45], v7 offset:32768
    ds_read_b64_tr_b16 v[46:47], v7 offset:33024
    ds_read_b64_tr_b16 v[48:49], v7 offset:36864
    ds_read_b64_tr_b16 v[50:51], v7 offset:37120
    ds_read_b64_tr_b16 v[52:53], v7 offset:40960
    ds_read_b64_tr_b16 v[54:55], v7 offset:41216
    s_cmp_eq_u32 s49, 1
    s_cbranch_scc1 PB_L7_1
    s_cmp_eq_u32 s49, 2
    s_cbranch_scc1 PB_L7_2
    s_cmp_eq_u32 s49, 3
    s_cbranch_scc1 PB_L7_3
PB_L7_0:
    s_waitcnt lgkmcnt(12)
    v_mfma_f32_16x16x32_bf16 v[8:11], v[28:31], v[16:19], v[8:11]
    v_mfma_f32_32x32x16_bf16 v[56:71], v[28:31], v[20:23], v[56:71]
    ds_read_b128 v[24:27], v4
    ds_read_b64_tr_b16 v[28:29], v7 offset:17408
    ds_read_b64_tr_b16 v[30:31], v7 offset:17664
    s_waitcnt lgkmcnt(13)
    v_mfma_f32_32x32x16_bf16 v[72:87], v[32:35], v[20:23], v[72:87]
    ds_read_b64_tr_b16 v[32:33], v7 offset:21504
    ds_read_b64_tr_b16 v[34:35], v7 offset:21760
    s_waitcnt lgkmcnt(13)
    v_mfma_f32_32x32x16_bf16 v[88:103], v[20:23], v[36:39], v[88:103]
    ds_read_b64_tr_b16 v[36:37], v7 offset:25600
    ds_read_b64_tr_b16 v[38:39], v7 offset:25856
    s_waitcnt lgkmcnt(13)
    v_mfma_f32_32x32x16_bf16 v[104:119], v[40:43], v[20:23], v[104:119]
    ds_read_b64_tr_b16 v[40:41], v7 offset:29696
    ds_read_b64_tr_b16 v[42:43], v7 offset:29952
    s_waitcnt lgkmcnt(13)
    v_mfma_f32_16x16x32_bf16 v[12:15], v[44:47], v[16:19], v[12:15]
    v_mfma_f32_32x32x16_bf16 v[120:135], v[44:47], v[20:23], v[120:135]
    ds_read_b64_tr_b16 v[44:45], v7 offset:33792
    ds_read_b64_tr_b16 v[46:47], v7 offset:34048
    s_waitcnt lgkmcnt(13)
    v_mfma_f32_32x32x16_bf16 v[136:151], v[48:51], v[20:23], v[136:151]
    ds_read_b64_tr_b16 v[48:49], v7 offset:37888
    ds_read_b64_tr_b16 v[50:51], v7 offset:38144
    s_waitcnt lgkmcnt(13)
    v_mfma_f32_32x32x16_bf16 v[152:167], v[52:55], v[20:23], v[152:167]
    ds_read_b64_tr_b16 v[52:53], v7 offset:41984
    ds_read_b64_tr_b16 v[54:55], v7 offset:42240
    s_waitcnt lgkmcnt(12)
    v_mfma_f32_16x16x32_bf16 v[8:11], v[28:31], v[16:19], v[8:11]
    v_mfma_f32_32x32x16_bf16 v[56:71], v[28:31], v[24:27], v[56:71]
    ds_read_b128 v[20:23], v5
    ds_read_b64_tr_b16 v[28:29], v7 offset:18432
    ds_read_b64_tr_b16 v[30:31], v7 offset:18688
    s_waitcnt lgkmcnt(13)
    v_mfma_f32_32x32x16_bf16 v[72:87], v[32:35], v[24:27], v[72:87]
    ds_read_b64_tr_b16 v[32:33], v7 offset:22528
    ds_read_b64_tr_b16 v[34:35], v7 offset:22784
    s_waitcnt lgkmcnt(13)
    v_mfma_f32_32x32x16_bf16 v[88:103], v[24:27], v[36:39], v[88:103]
    ds_read_b64_tr_b16 v[36:37], v7 offset:26624
    ds_read_b64_tr_b16 v[38:39], v7 offset:26880
    s_waitcnt lgkmcnt(13)
    v_mfma_f32_32x32x16_bf16 v[104:119], v[40:43], v[24:27], v[104:119]
    ds_read_b64_tr_b16 v[40:41], v7 offset:30720
    ds_read_b64_tr_b16 v[42:43], v7 offset:30976
    s_waitcnt lgkmcnt(13)
    v_mfma_f32_16x16x32_bf16 v[12:15], v[44:47], v[16:19], v[12:15]
    v_mfma_f32_32x32x16_bf16 v[120:135], v[44:47], v[24:27], v[120:135]
    ds_read_b64_tr_b16 v[44:45], v7 offset:34816
    ds_read_b64_tr_b16 v[46:47], v7 offset:35072
    s_waitcnt lgkmcnt(13)
    v_mfma_f32_32x32x16_bf16 v[136:151], v[48:51], v[24:27], v[136:151]
    ds_read_b64_tr_b16 v[48:49], v7 offset:38912
    ds_read_b64_tr_b16 v[50:51], v7 offset:39168
    s_waitcnt lgkmcnt(13)
    v_mfma_f32_32x32x16_bf16 v[152:167], v[52:55], v[24:27], v[152:167]
    ds_read_b64_tr_b16 v[52:53], v7 offset:43008
    ds_read_b64_tr_b16 v[54:55], v7 offset:43264
    s_waitcnt lgkmcnt(12)
    v_mfma_f32_16x16x32_bf16 v[8:11], v[28:31], v[16:19], v[8:11]
    v_mfma_f32_32x32x16_bf16 v[56:71], v[28:31], v[20:23], v[56:71]
    ds_read_b128 v[24:27], v6
    ds_read_b64_tr_b16 v[28:29], v7 offset:19456
    ds_read_b64_tr_b16 v[30:31], v7 offset:19712
    s_waitcnt lgkmcnt(13)
    v_mfma_f32_32x32x16_bf16 v[72:87], v[32:35], v[20:23], v[72:87]
    ds_read_b64_tr_b16 v[32:33], v7 offset:23552
    ds_read_b64_tr_b16 v[34:35], v7 offset:23808
    s_waitcnt lgkmcnt(13)
    v_mfma_f32_32x32x16_bf16 v[88:103], v[20:23], v[36:39], v[88:103]
    ds_read_b64_tr_b16 v[36:37], v7 offset:27648
    ds_read_b64_tr_b16 v[38:39], v7 offset:27904
    s_waitcnt lgkmcnt(13)
    v_mfma_f32_32x32x16_bf16 v[104:119], v[40:43], v[20:23], v[104:119]
    ds_read_b64_tr_b16 v[40:41], v7 offset:31744
    ds_read_b64_tr_b16 v[42:43], v7 offset:32000
    s_waitcnt lgkmcnt(13)
    v_mfma_f32_16x16x32_bf16 v[12:15], v[44:47], v[16:19], v[12:15]
    v_mfma_f32_32x32x16_bf16 v[120:135], v[44:47], v[20:23], v[120:135]
    ds_read_b64_tr_b16 v[44:45], v7 offset:35840
    ds_read_b64_tr_b16 v[46:47], v7 offset:36096
    s_waitcnt lgkmcnt(13)
    v_mfma_f32_32x32x16_bf16 v[136:151], v[48:51], v[20:23], v[136:151]
    ds_read_b64_tr_b16 v[48:49], v7 offset:39936
    ds_read_b64_tr_b16 v[50:51], v7 offset:40192
    s_waitcnt lgkmcnt(13)
    v_mfma_f32_32x32x16_bf16 v[152:167], v[52:55], v[20:23], v[152:167]
    ds_read_b64_tr_b16 v[52:53], v7 offset:44032
    ds_read_b64_tr_b16 v[54:55], v7 offset:44288
    s_waitcnt lgkmcnt(12)
    v_mfma_f32_16x16x32_bf16 v[8:11], v[28:31], v[16:19], v[8:11]
    v_mfma_f32_32x32x16_bf16 v[56:71], v[28:31], v[24:27], v[56:71]
    s_cmp_eq_u32 s71, 2
    s_mov_b32 s54, 45056
    s_cmov_b32 s54, -90112
    v_add_u32 v3, s54, v3
    v_add_u32 v4, s54, v4
    v_add_u32 v7, s54, v7
    s_waitcnt lgkmcnt(10)
    v_mfma_f32_32x32x16_bf16 v[72:87], v[32:35], v[24:27], v[72:87]
    v_add_u32 v5, s54, v5
    v_add_u32 v6, s54, v6
    s_waitcnt lgkmcnt(8)
    v_mfma_f32_32x32x16_bf16 v[88:103], v[24:27], v[36:39], v[88:103]
    s_waitcnt lgkmcnt(0)
    s_barrier
    ds_read_b128 v[20:23], v3
    ds_read_b64_tr_b16 v[28:29], v7 offset:16384
    ds_read_b64_tr_b16 v[30:31], v7 offset:16640
    ds_read_b64_tr_b16 v[32:33], v7 offset:20480
    ds_read_b64_tr_b16 v[34:35], v7 offset:20736
    ds_read_b64_tr_b16 v[36:37], v7 offset:24576
    ds_read_b64_tr_b16 v[38:39], v7 offset:24832
    v_mfma_f32_32x32x16_bf16 v[104:119], v[40:43], v[24:27], v[104:119]
    ds_read_b64_tr_b16 v[40:41], v7 offset:28672
    ds_read_b64_tr_b16 v[42:43], v7 offset:28928
    v_mfma_f32_16x16x32_bf16 v[12:15], v[44:47], v[16:19], v[12:15]
    v_mfma_f32_32x32x16_bf16 v[120:135], v[44:47], v[24:27], v[120:135]
    ds_read_b64_tr_b16 v[44:45], v7 offset:32768
    ds_read_b64_tr_b16 v[46:47], v7 offset:33024
    v_mfma_f32_32x32x16_bf16 v[136:151], v[48:51], v[24:27], v[136:151]
    ds_read_b64_tr_b16 v[48:49], v7 offset:36864
    ds_read_b64_tr_b16 v[50:51], v7 offset:37120
    v_mfma_f32_32x32x16_bf16 v[152:167], v[52:55], v[24:27], v[152:167]
    ds_read_b64_tr_b16 v[52:53], v7 offset:40960
    ds_read_b64_tr_b16 v[54:55], v7 offset:41216
    s_add_u32 s71, s71, 1
    s_cmp_eq_u32 s71, 3
    s_cselect_b32 s71, 0, s71
    s_add_u32 s26, s26, 1
    s_cmp_lt_u32 s26, 8
    s_cbranch_scc1 PB_L7_0
    s_branch PB_EPI
PB_L7_1:
    s_waitcnt lgkmcnt(12)
    v_mfma_f32_32x32x16_bf16 v[56:71], v[28:31], v[20:23], v[56:71]
    ds_read_b128 v[24:27], v4
    ds_read_b64_tr_b16 v[28:29], v7 offset:17408
    ds_read_b64_tr_b16 v[30:31], v7 offset:17664
    s_waitcnt lgkmcnt(13)
    v_mfma_f32_16x16x32_bf16 v[8:11], v[32:35], v[16:19], v[8:11]
    v_mfma_f32_32x32x16_bf16 v[72:87], v[32:35], v[20:23], v[72:87]
    ds_read_b64_tr_b16 v[32:33], v7 offset:21504
    ds_read_b64_tr_b16 v[34:35], v7 offset:21760
    s_waitcnt lgkmcnt(13)
    v_mfma_f32_32x32x16_bf16 v[88:103], v[20:23], v[36:39], v[88:103]
    ds_read_b64_tr_b16 v[36:37], v7 offset:25600
    ds_read_b64_tr_b16 v[38:39], v7 offset:25856
    s_waitcnt lgkmcnt(13)
    v_mfma_f32_32x32x16_bf16 v[104:119], v[40:43], v[20:23], v[104:119]
    ds_read_b64_tr_b16 v[40:41], v7 offset:29696
    ds_read_b64_tr_b16 v[42:43], v7 offset:29952
    s_waitcnt lgkmcnt(13)
    v_mfma_f32_32x32x16_bf16 v[120:135], v[44:47], v[20:23], v[120:135]
    ds_read_b64_tr_b16 v[44:45], v7 offset:33792
    ds_read_b64_tr_b16 v[46:47], v7 offset:34048
    s_waitcnt lgkmcnt(13)
    v_mfma_f32_16x16x32_bf16 v[12:15], v[48:51], v[16:19], v[12:15]
    v_mfma_f32_32x32x16_bf16 v[136:151], v[48:51], v[20:23], v[136:151]
    ds_read_b64_tr_b16 v[48:49], v7 offset:37888
    ds_read_b64_tr_b16 v[50:51], v7 offset:38144
    s_waitcnt lgkmcnt(13)
    v_mfma_f32_32x32x16_bf16 v[152:167], v[52:55], v[20:23], v[152:167]
    ds_read_b64_tr_b16 v[52:53], v7 offset:41984
    ds_read_b64_tr_b16 v[54:55], v7 offset:42240
    s_waitcnt lgkmcnt(12)
    v_mfma_f32_32x32x16_bf16 v[56:71], v[28:31], v[24:27], v[56:71]
    ds_read_b128 v[20:23], v5
    ds_read_b64_tr_b16 v[28:29], v7 offset:18432
    ds_read_b64_tr_b16 v[30:31], v7 offset:18688
    s_waitcnt lgkmcnt(13)
    v_mfma_f32_16x16x32_bf16 v[8:11], v[32:35], v[16:19], v[8:11]
    v_mfma_f32_32x32x16_bf16 v[72:87], v[32:35], v[24:27], v[72:87]
    ds_read_b64_tr_b16 v[32:33], v7 offset:22528
    ds_read_b64_tr_b16 v[34:35], v7 offset:22784
    s_waitcnt lgkmcnt(13)
    v_mfma_f32_32x32x16_bf16 v[88:103], v[24:27], v[36:39], v[88:103]
    ds_read_b64_tr_b16 v[36:37], v7 offset:26624
    ds_read_b64_tr_b16 v[38:39], v7 offset:26880
    s_waitcnt lgkmcnt(13)
    v_mfma_f32_32x32x16_bf16 v[104:119], v[40:43], v[24:27], v[104:119]
    ds_read_b64_tr_b16 v[40:41], v7 offset:30720
    ds_read_b64_tr_b16 v[42:43], v7 offset:30976
    s_waitcnt lgkmcnt(13)
    v_mfma_f32_32x32x16_bf16 v[120:135], v[44:47], v[24:27], v[120:135]
    ds_read_b64_tr_b16 v[44:45], v7 offset:34816
    ds_read_b64_tr_b16 v[46:47], v7 offset:35072
    s_waitcnt lgkmcnt(13)
    v_mfma_f32_16x16x32_bf16 v[12:15], v[48:51], v[16:19], v[12:15]
    v_mfma_f32_32x32x16_bf16 v[136:151], v[48:51], v[24:27], v[136:151]
    ds_read_b64_tr_b16 v[48:49], v7 offset:38912
    ds_read_b64_tr_b16 v[50:51], v7 offset:39168
    s_waitcnt lgkmcnt(13)
    v_mfma_f32_32x32x16_bf16 v[152:167], v[52:55], v[24:27], v[152:167]
    ds_read_b64_tr_b16 v[52:53], v7 offset:43008
    ds_read_b64_tr_b16 v[54:55], v7 offset:43264
    s_waitcnt lgkmcnt(12)
    v_mfma_f32_32x32x16_bf16 v[56:71], v[28:31], v[20:23], v[56:71]
    ds_read_b128 v[24:27], v6
    ds_read_b64_tr_b16 v[28:29], v7 offset:19456
    ds_read_b64_tr_b16 v[30:31], v7 offset:19712
    s_waitcnt lgkmcnt(13)
    v_mfma_f32_16x16x32_bf16 v[8:11], v[32:35], v[16:19], v[8:11]
    v_mfma_f32_32x32x16_bf16 v[72:87], v[32:35], v[20:23], v[72:87]
    ds_read_b64_tr_b16 v[32:33], v7 offset:23552
    ds_read_b64_tr_b16 v[34:35], v7 offset:23808
    s_waitcnt lgkmcnt(13)
    v_mfma_f32_32x32x16_bf16 v[88:103], v[20:23], v[36:39], v[88:103]
    ds_read_b64_tr_b16 v[36:37], v7 offset:27648
    ds_read_b64_tr_b16 v[38:39], v7 offset:27904
    s_waitcnt lgkmcnt(13)
    v_mfma_f32_32x32x16_bf16 v[104:119], v[40:43], v[20:23], v[104:119]
    ds_read_b64_tr_b16 v[40:41], v7 offset:31744
    ds_read_b64_tr_b16 v[42:43], v7 offset:32000
    s_waitcnt lgkmcnt(13)
    v_mfma_f32_32x32x16_bf16 v[120:135], v[44:47], v[20:23], v[120:135]
    ds_read_b64_tr_b16 v[44:45], v7 offset:35840
    ds_read_b64_tr_b16 v[46:47], v7 offset:36096
    s_waitcnt lgkmcnt(13)
    v_mfma_f32_16x16x32_bf16 v[12:15], v[48:51], v[16:19], v[12:15]
    v_mfma_f32_32x32x16_bf16 v[136:151], v[48:51], v[20:23], v[136:151]
    ds_read_b64_tr_b16 v[48:49], v7 offset:39936
    ds_read_b64_tr_b16 v[50:51], v7 offset:40192
    s_waitcnt lgkmcnt(13)
    v_mfma_f32_32x32x16_bf16 v[152:167], v[52:55], v[20:23], v[152:167]
    ds_read_b64_tr_b16 v[52:53], v7 offset:44032
    ds_read_b64_tr_b16 v[54:55], v7 offset:44288
    s_waitcnt lgkmcnt(12)
    v_mfma_f32_32x32x16_bf16 v[56:71], v[28:31], v[24:27], v[56:71]
    s_cmp_eq_u32 s71, 2
    s_mov_b32 s54, 45056
    s_cmov_b32 s54, -90112
    v_add_u32 v3, s54, v3
    v_add_u32 v4, s54, v4
    v_add_u32 v7, s54, v7
    s_waitcnt lgkmcnt(10)
    v_mfma_f32_16x16x32_bf16 v[8:11], v[32:35], v[16:19], v[8:11]
    v_mfma_f32_32x32x16_bf16 v[72:87], v[32:35], v[24:27], v[72:87]
    v_add_u32 v5, s54, v5
    v_add_u32 v6, s54, v6
    s_waitcnt lgkmcnt(8)
    v_mfma_f32_32x32x16_bf16 v[88:103], v[24:27], v[36:39], v[88:103]
    s_waitcnt lgkmcnt(0)
    s_barrier
    ds_read_b128 v[20:23], v3
    ds_read_b64_tr_b16 v[28:29], v7 offset:16384
    ds_read_b64_tr_b16 v[30:31], v7 offset:16640
    ds_read_b64_tr_b16 v[32:33], v7 offset:20480
    ds_read_b64_tr_b16 v[34:35], v7 offset:20736
    ds_read_b64_tr_b16 v[36:37], v7 offset:24576
    ds_read_b64_tr_b16 v[38:39], v7 offset:24832
    v_mfma_f32_32x32x16_bf16 v[104:119], v[40:43], v[24:27], v[104:119]
    ds_read_b64_tr_b16 v[40:41], v7 offset:28672
    ds_read_b64_tr_b16 v[42:43], v7 offset:28928
    v_mfma_f32_32x32x16_bf16 v[120:135], v[44:47], v[24:27], v[120:135]
    ds_read_b64_tr_b16 v[44:45], v7 offset:32768
    ds_read_b64_tr_b16 v[46:47], v7 offset:33024
    v_mfma_f32_16x16x32_bf16 v[12:15], v[48:51], v[16:19], v[12:15]
    v_mfma_f32_32x32x16_bf16 v[136:151], v[48:51], v[24:27], v[136:151]
    ds_read_b64_tr_b16 v[48:49], v7 offset:36864
    ds_read_b64_tr_b16 v[50:51], v7 offset:37120
    v_mfma_f32_32x32x16_bf16 v[152:167], v[52:55], v[24:27], v[152:167]
    ds_read_b64_tr_b16 v[52:53], v7 offset:40960
    ds_read_b64_tr_b16 v[54:55], v7 offset:41216
    s_add_u32 s71, s71, 1
    s_cmp_eq_u32 s71, 3
    s_cselect_b32 s71, 0, s71
    s_add_u32 s26, s26, 1
    s_cmp_lt_u32 s26, 8
    s_cbranch_scc1 PB_L7_1
    s_branch PB_EPI
PB_L7_2:
    s_waitcnt lgkmcnt(12)
    v_mfma_f32_32x32x16_bf16 v[56:71], v[28:31], v[20:23], v[56:71]
    ds_read_b128 v[24:27], v4
    ds_read_b64_tr_b16 v[28:29], v7 offset:17408
    ds_read_b64_tr_b16 v[30:31], v7 offset:17664
    s_waitcnt lgkmcnt(13)
    v_mfma_f32_32x32x16_bf16 v[72:87], v[32:35], v[20:23], v[72:87]
    ds_read_b64_tr_b16 v[32:33], v7 offset:21504
    ds_read_b64_tr_b16 v[34:35], v7 offset:21760
    s_waitcnt lgkmcnt(13)
    v_mfma_f32_16x16x32_bf16 v[8:11], v[36:39], v[16:19], v[8:11]
    v_mfma_f32_32x32x16_bf16 v[88:103], v[20:23], v[36:39], v[88:103]
    ds_read_b64_tr_b16 v[36:37], v7 offset:25600
    ds_read_b64_tr_b16 v[38:39], v7 offset:25856
    s_waitcnt lgkmcnt(13)
    v_mfma_f32_32x32x16_bf16 v[104:119], v[40:43], v[20:23], v[104:119]
    ds_read_b64_tr_b16 v[40:41], v7 offset:29696
    ds_read_b64_tr_b16 v[42:43], v7 offset:29952
    s_waitcnt lgkmcnt(13)
    v_mfma_f32_32x32x16_bf16 v[120:135], v[44:47], v[20:23], v[120:135]
    ds_read_b64_tr_b16 v[44:45], v7 offset:33792
    ds_read_b64_tr_b16 v[46:47], v7 offset:34048
    s_waitcnt lgkmcnt(13)
    v_mfma_f32_32x32x16_bf16 v[136:151], v[48:51], v[20:23], v[136:151]
    ds_read_b64_tr_b16 v[48:49], v7 offset:37888
    ds_read_b64_tr_b16 v[50:51], v7 offset:38144
    s_waitcnt lgkmcnt(13)
    v_mfma_f32_16x16x32_bf16 v[12:15], v[52:55], v[16:19], v[12:15]
    v_mfma_f32_32x32x16_bf16 v[152:167], v[52:55], v[20:23], v[152:167]
    ds_read_b64_tr_b16 v[52:53], v7 offset:41984
    ds_read_b64_tr_b16 v[54:55], v7 offset:42240
    s_waitcnt lgkmcnt(12)
    v_mfma_f32_32x32x16_bf16 v[56:71], v[28:31], v[24:27], v[56:71]
    ds_read_b128 v[20:23], v5
    ds_read_b64_tr_b16 v[28:29], v7 offset:18432
    ds_read_b64_tr_b16 v[30:31], v7 offset:18688
    s_waitcnt lgkmcnt(13)
    v_mfma_f32_32x32x16_bf16 v[72:87], v[32:35], v[24:27], v[72:87]
    ds_read_b64_tr_b16 v[32:33], v7 offset:22528
    ds_read_b64_tr_b16 v[34:35], v7 offset:22784
    s_waitcnt lgkmcnt(13)
    v_mfma_f32_16x16x32_bf16 v[8:11], v[36:39], v[16:19], v[8:11]
    v_mfma_f32_32x32x16_bf16 v[88:103], v[24:27], v[36:39], v[88:103]
    ds_read_b64_tr_b16 v[36:37], v7 offset:26624
    ds_read_b64_tr_b16 v[38:39], v7 offset:26880
    s_waitcnt lgkmcnt(13)
    v_mfma_f32_32x32x16_bf16 v[104:119], v[40:43], v[24:27], v[104:119]
    ds_read_b64_tr_b16 v[40:41], v7 offset:30720
    ds_read_b64_tr_b16 v[42:43], v7 offset:30976
    s_waitcnt lgkmcnt(13)
    v_mfma_f32_32x32x16_bf16 v[120:135], v[44:47], v[24:27], v[120:135]
    ds_read_b64_tr_b16 v[44:45], v7 offset:34816
    ds_read_b64_tr_b16 v[46:47], v7 offset:35072
    s_waitcnt lgkmcnt(13)
    v_mfma_f32_32x32x16_bf16 v[136:151], v[48:51], v[24:27], v[136:151]
    ds_read_b64_tr_b16 v[48:49], v7 offset:38912
    ds_read_b64_tr_b16 v[50:51], v7 offset:39168
    s_waitcnt lgkmcnt(13)
    v_mfma_f32_16x16x32_bf16 v[12:15], v[52:55], v[16:19], v[12:15]
    v_mfma_f32_32x32x16_bf16 v[152:167], v[52:55], v[24:27], v[152:167]
    ds_read_b64_tr_b16 v[52:53], v7 offset:43008
    ds_read_b64_tr_b16 v[54:55], v7 offset:43264
    s_waitcnt lgkmcnt(12)
    v_mfma_f32_32x32x16_bf16 v[56:71], v[28:31], v[20:23], v[56:71]
    ds_read_b128 v[24:27], v6
    ds_read_b64_tr_b16 v[28:29], v7 offset:19456
    ds_read_b64_tr_b16 v[30:31], v7 offset:19712
    s_waitcnt lgkmcnt(13)
    v_mfma_f32_32x32x16_bf16 v[72:87], v[32:35], v[20:23], v[72:87]
    ds_read_b64_tr_b16 v[32:33], v7 offset:23552
    ds_read_b64_tr_b16 v[34:35], v7 offset:23808
    s_waitcnt lgkmcnt(13)
    v_mfma_f32_16x16x32_bf16 v[8:11], v[36:39], v[16:19], v[8:11]
    v_mfma_f32_32x32x16_bf16 v[88:103], v[20:23], v[36:39], v[88:103]
    ds_read_b64_tr_b16 v[36:37], v7 offset:27648
    ds_read_b64_tr_b16 v[38:39], v7 offset:27904
    s_waitcnt lgkmcnt(13)
    v_mfma_f32_32x32x16_bf16 v[104:119], v[40:43], v[20:23], v[104:119]
    ds_read_b64_tr_b16 v[40:41], v7 offset:31744
    ds_read_b64_tr_b16 v[42:43], v7 offset:32000
    s_waitcnt lgkmcnt(13)
    v_mfma_f32_32x32x16_bf16 v[120:135], v[44:47], v[20:23], v[120:135]
    ds_read_b64_tr_b16 v[44:45], v7 offset:35840
    ds_read_b64_tr_b16 v[46:47], v7 offset:36096
    s_waitcnt lgkmcnt(13)
    v_mfma_f32_32x32x16_bf16 v[136:151], v[48:51], v[20:23], v[136:151]
    ds_read_b64_tr_b16 v[48:49], v7 offset:39936
    ds_read_b64_tr_b16 v[50:51], v7 offset:40192
    s_waitcnt lgkmcnt(13)
    v_mfma_f32_16x16x32_bf16 v[12:15], v[52:55], v[16:19], v[12:15]
    v_mfma_f32_32x32x16_bf16 v[152:167], v[52:55], v[20:23], v[152:167]
    ds_read_b64_tr_b16 v[52:53], v7 offset:44032
    ds_read_b64_tr_b16 v[54:55], v7 offset:44288
    s_waitcnt lgkmcnt(12)
    v_mfma_f32_32x32x16_bf16 v[56:71], v[28:31], v[24:27], v[56:71]
    s_cmp_eq_u32 s71, 2
    s_mov_b32 s54, 45056
    s_cmov_b32 s54, -90112
    v_add_u32 v3, s54, v3
    v_add_u32 v4, s54, v4
    v_add_u32 v7, s54, v7
    s_waitcnt lgkmcnt(10)
    v_mfma_f32_32x32x16_bf16 v[72:87], v[32:35], v[24:27], v[72:87]
    v_add_u32 v5, s54, v5
    v_add_u32 v6, s54, v6
    s_waitcnt lgkmcnt(8)
    v_mfma_f32_16x16x32_bf16 v[8:11], v[36:39], v[16:19], v[8:11]
    v_mfma_f32_32x32x16_bf16 v[88:103], v[24:27], v[36:39], v[88:103]
    s_waitcnt lgkmcnt(0)
    s_barrier
    ds_read_b128 v[20:23], v3
    ds_read_b64_tr_b16 v[28:29], v7 offset:16384
    ds_read_b64_tr_b16 v[30:31], v7 offset:16640
    ds_read_b64_tr_b16 v[32:33], v7 offset:20480
    ds_read_b64_tr_b16 v[34:35], v7 offset:20736
    ds_read_b64_tr_b16 v[36:37], v7 offset:24576
    ds_read_b64_tr_b16 v[38:39], v7 offset:24832
    v_mfma_f32_32x32x16_bf16 v[104:119], v[40:43], v[24:27], v[104:119]
    ds_read_b64_tr_b16 v[40:41], v7 offset:28672
    ds_read_b64_tr_b16 v[42:43], v7 offset:28928
    v_mfma_f32_32x32x16_bf16 v[120:135], v[44:47], v[24:27], v[120:135]
    ds_read_b64_tr_b16 v[44:45], v7 offset:32768
    ds_read_b64_tr_b16 v[46:47], v7 offset:33024
    v_mfma_f32_32x32x16_bf16 v[136:151], v[48:51], v[24:27], v[136:151]
    ds_read_b64_tr_b16 v[48:49], v7 offset:36864
    ds_read_b64_tr_b16 v[50:51], v7 offset:37120
    v_mfma_f32_16x16x32_bf16 v[12:15], v[52:55], v[16:19], v[12:15]
    v_mfma_f32_32x32x16_bf16 v[152:167], v[52:55], v[24:27], v[152:167]
    ds_read_b64_tr_b16 v[52:53], v7 offset:40960
    ds_read_b64_tr_b16 v[54:55], v7 offset:41216
    s_add_u32 s71, s71, 1
    s_cmp_eq_u32 s71, 3
    s_cselect_b32 s71, 0, s71
    s_add_u32 s26, s26, 1
    s_cmp_lt_u32 s26, 8
    s_cbranch_scc1 PB_L7_2
    s_branch PB_EPI
PB_L7_3:
    s_waitcnt lgkmcnt(12)
    v_mfma_f32_32x32x16_bf16 v[56:71], v[28:31], v[20:23], v[56:71]
    ds_read_b128 v[24:27], v4
    ds_read_b64_tr_b16 v[28:29], v7 offset:17408
    ds_read_b64_tr_b16 v[30:31], v7 offset:17664
    s_waitcnt lgkmcnt(13)
    v_mfma_f32_32x32x16_bf16 v[72:87], v[32:35], v[20:23], v[72:87]
    ds_read_b64_tr_b16 v[32:33], v7 offset:21504
    ds_read_b64_tr_b16 v[34:35], v7 offset:21760
    s_waitcnt lgkmcnt(13)
    v_mfma_f32_32x32x16_bf16 v[88:103], v[20:23], v[36:39], v[88:103]
    ds_read_b64_tr_b16 v[36:37], v7 offset:25600
    ds_read_b64_tr_b16 v[38:39], v7 offset:25856
    s_waitcnt lgkmcnt(13)
    v_mfma_f32_16x16x32_bf16 v[8:11], v[40:43], v[16:19], v[8:11]
    v_mfma_f32_32x32x16_bf16 v[104:119], v[40:43], v[20:23], v[104:119]
    ds_read_b64_tr_b16 v[40:41], v7 offset:29696
    ds_read_b64_tr_b16 v[42:43], v7 offset:29952
    s_waitcnt lgkmcnt(13)
    v_mfma_f32_32x32x16_bf16 v[120:135], v[44:47], v[20:23], v[120:135]
    ds_read_b64_tr_b16 v[44:45], v7 offset:33792
    ds_read_b64_tr_b16 v[46:47], v7 offset:34048
    s_waitcnt lgkmcnt(13)
    v_mfma_f32_32x32x16_bf16 v[136:151], v[48:51], v[20:23], v[136:151]
    ds_read_b64_tr_b16 v[48:49], v7 offset:37888
    ds_read_b64_tr_b16 v[50:51], v7 offset:38144
    s_waitcnt lgkmcnt(13)
    v_mfma_f32_32x32x16_bf16 v[152:167], v[52:55], v[20:23], v[152:167]
    ds_read_b64_tr_b16 v[52:53], v7 offset:41984
    ds_read_b64_tr_b16 v[54:55], v7 offset:42240
    s_waitcnt lgkmcnt(12)
    v_mfma_f32_32x32x16_bf16 v[56:71], v[28:31], v[24:27], v[56:71]
    ds_read_b128 v[20:23], v5
    ds_read_b64_tr_b16 v[28:29], v7 offset:18432
    ds_read_b64_tr_b16 v[30:31], v7 offset:18688
    s_waitcnt lgkmcnt(13)
    v_mfma_f32_32x32x16_bf16 v[72:87], v[32:35], v[24:27], v[72:87]
    ds_read_b64_tr_b16 v[32:33], v7 offset:22528
    ds_read_b64_tr_b16 v[34:35], v7 offset:22784
    s_waitcnt lgkmcnt(13)
    v_mfma_f32_32x32x16_bf16 v[88:103], v[24:27], v[36:39], v[88:103]
    ds_read_b64_tr_b16 v[36:37], v7 offset:26624
    ds_read_b64_tr_b16 v[38:39], v7 offset:26880
    s_waitcnt lgkmcnt(13)
    v_mfma_f32_16x16x32_bf16 v[8:11], v[40:43], v[16:19], v[8:11]
    v_mfma_f32_32x32x16_bf16 v[104:119], v[40:43], v[24:27], v[104:119]
    ds_read_b64_tr_b16 v[40:41], v7 offset:30720
    ds_read_b64_tr_b16 v[42:43], v7 offset:30976
    s_waitcnt lgkmcnt(13)
    v_mfma_f32_32x32x16_bf16 v[120:135], v[44:47], v[24:27], v[120:135]
    ds_read_b64_tr_b16 v[44:45], v7 offset:34816
    ds_read_b64_tr_b16 v[46:47], v7 offset:35072
    s_waitcnt lgkmcnt(13)
    v_mfma_f32_32x32x16_bf16 v[136:151], v[48:51], v[24:27], v[136:151]
    ds_read_b64_tr_b16 v[48:49], v7 offset:38912
    ds_read_b64_tr_b16 v[50:51], v7 offset:39168
    s_waitcnt lgkmcnt(13)
    v_mfma_f32_32x32x16_bf16 v[152:167], v[52:55], v[24:27], v[152:167]
    ds_read_b64_tr_b16 v[52:53], v7 offset:43008
    ds_read_b64_tr_b16 v[54:55], v7 offset:43264
    s_waitcnt lgkmcnt(12)
    v_mfma_f32_32x32x16_bf16 v[56:71], v[28:31], v[20:23], v[56:71]
    ds_read_b128 v[24:27], v6
    ds_read_b64_tr_b16 v[28:29], v7 offset:19456
    ds_read_b64_tr_b16 v[30:31], v7 offset:19712
    s_waitcnt lgkmcnt(13)
    v_mfma_f32_32x32x16_bf16 v[72:87], v[32:35], v[20:23], v[72:87]
    ds_read_b64_tr_b16 v[32:33], v7 offset:23552
    ds_read_b64_tr_b16 v[34:35], v7 offset:23808
    s_waitcnt lgkmcnt(13)
    v_mfma_f32_32x32x16_bf16 v[88:103], v[20:23], v[36:39], v[88:103]
    ds_read_b64_tr_b16 v[36:37], v7 offset:27648
    ds_read_b64_tr_b16 v[38:39], v7 offset:27904
    s_waitcnt lgkmcnt(13)
    v_mfma_f32_16x16x32_bf16 v[8:11], v[40:43], v[16:19], v[8:11]
    v_mfma_f32_32x32x16_bf16 v[104:119], v[40:43], v[20:23], v[104:119]
    ds_read_b64_tr_b16 v[40:41], v7 offset:31744
    ds_read_b64_tr_b16 v[42:43], v7 offset:32000
    s_waitcnt lgkmcnt(13)
    v_mfma_f32_32x32x16_bf16 v[120:135], v[44:47], v[20:23], v[120:135]
    ds_read_b64_tr_b16 v[44:45], v7 offset:35840
    ds_read_b64_tr_b16 v[46:47], v7 offset:36096
    s_waitcnt lgkmcnt(13)
    v_mfma_f32_32x32x16_bf16 v[136:151], v[48:51], v[20:23], v[136:151]
    ds_read_b64_tr_b16 v[48:49], v7 offset:39936
    ds_read_b64_tr_b16 v[50:51], v7 offset:40192
    s_waitcnt lgkmcnt(13)
    v_mfma_f32_32x32x16_bf16 v[152:167], v[52:55], v[20:23], v[152:167]
    ds_read_b64_tr_b16 v[52:53], v7 offset:44032
    ds_read_b64_tr_b16 v[54:55], v7 offset:44288
    s_waitcnt lgkmcnt(12)
    v_mfma_f32_32x32x16_bf16 v[56:71], v[28:31], v[24:27], v[56:71]
    s_cmp_eq_u32 s71, 2
    s_mov_b32 s54, 45056
    s_cmov_b32 s54, -90112
    v_add_u32 v3, s54, v3
    v_add_u32 v4, s54, v4
    v_add_u32 v7, s54, v7
    s_waitcnt lgkmcnt(10)
    v_mfma_f32_32x32x16_bf16 v[72:87], v[32:35], v[24:27], v[72:87]
    v_add_u32 v5, s54, v5
    v_add_u32 v6, s54, v6
    s_waitcnt lgkmcnt(8)
    v_mfma_f32_32x32x16_bf16 v[88:103], v[24:27], v[36:39], v[88:103]
    s_waitcnt lgkmcnt(0)
    s_barrier
    ds_read_b128 v[20:23], v3
    ds_read_b64_tr_b16 v[28:29], v7 offset:16384
    ds_read_b64_tr_b16 v[30:31], v7 offset:16640
    ds_read_b64_tr_b16 v[32:33], v7 offset:20480
    ds_read_b64_tr_b16 v[34:35], v7 offset:20736
    ds_read_b64_tr_b16 v[36:37], v7 offset:24576
    ds_read_b64_tr_b16 v[38:39], v7 offset:24832
    v_mfma_f32_16x16x32_bf16 v[8:11], v[40:43], v[16:19], v[8:11]
    v_mfma_f32_32x32x16_bf16 v[104:119], v[40:43], v[24:27], v[104:119]
    ds_read_b64_tr_b16 v[40:41], v7 offset:28672
    ds_read_b64_tr_b16 v[42:43], v7 offset:28928
    v_mfma_f32_32x32x16_bf16 v[120:135], v[44:47], v[24:27], v[120:135]
    ds_read_b64_tr_b16 v[44:45], v7 offset:32768
    ds_read_b64_tr_b16 v[46:47], v7 offset:33024
    v_mfma_f32_32x32x16_bf16 v[136:151], v[48:51], v[24:27], v[136:151]
    ds_read_b64_tr_b16 v[48:49], v7 offset:36864
    ds_read_b64_tr_b16 v[50:51], v7 offset:37120
    v_mfma_f32_32x32x16_bf16 v[152:167], v[52:55], v[24:27], v[152:167]
    ds_read_b64_tr_b16 v[52:53], v7 offset:40960
    ds_read_b64_tr_b16 v[54:55], v7 offset:41216
    s_add_u32 s71, s71, 1
    s_cmp_eq_u32 s71, 3
    s_cselect_b32 s71, 0, s71
    s_add_u32 s26, s26, 1
    s_cmp_lt_u32 s26, 8
    s_cbranch_scc1 PB_L7_3
    s_branch PB_EPI
PB_G6:
    s_barrier
    ds_read_b128 v[20:23], v3
    ds_read_b64_tr_b16 v[28:29], v7 offset:16384
    ds_read_b64_tr_b16 v[30:31], v7 offset:16640
    ds_read_b64_tr_b16 v[32:33], v7 offset:20480
    ds_read_b64_tr_b16 v[34:35], v7 offset:20736
    ds_read_b64_tr_b16 v[36:37], v7 offset:24576
    ds_read_b64_tr_b16 v[38:39], v7 offset:24832
    ds_read_b64_tr_b16 v[40:41], v7 offset:28672
    ds_read_b64_tr_b16 v[42:43], v7 offset:28928
    ds_read_b64_tr_b16 v[44:45], v7 offset:32768
    ds_read_b64_tr_b16 v[46:47], v7 offset:33024
    ds_read_b64_tr_b16 v[48:49], v7 offset:36864
    ds_read_b64_tr_b16 v[50:51], v7 offset:37120
    s_cmp_eq_u32 s49, 1
    s_cbranch_scc1 PB_L6_1
    s_cmp_eq_u32 s49, 2
    s_cbranch_scc1 PB_L6_2
    s_cmp_eq_u32 s49, 3
    s_cbranch_scc1 PB_L6_3
PB_L6_0:
    s_waitcnt lgkmcnt(10)
    v_mfma_f32_16x16x32_bf16 v[8:11], v[28:31], v[16:19], v[8:11]
    v_mfma_f32_32x32x16_bf16 v[56:71], v[28:31], v[20:23], v[56:71]
    ds_read_b128 v[24:27], v4
    ds_read_b64_tr_b16 v[28:29], v7 offset:17408
    ds_read_b64_tr_b16 v[30:31], v7 offset:17664
    s_waitcnt lgkmcnt(11)
    v_mfma_f32_32x32x16_bf16 v[72:87], v[32:35], v[20:23], v[72:87]
    ds_read_b64_tr_b16 v[32:33], v7 offset:21504
    ds_read_b64_tr_b16 v[34:35], v7 offset:21760
    s_waitcnt lgkmcnt(11)
    v_mfma_f32_32x32x16_bf16 v[88:103], v[20:23], v[36:39], v[88:103]
    ds_read_b64_tr_b16 v[36:37], v7 offset:25600
    ds_read_b64_tr_b16 v[38:39], v7 offset:25856
    s_waitcnt lgkmcnt(11)
    v_mfma_f32_32x32x16_bf16 v[104:119], v[40:43], v[20:23], v[104:119]
    ds_read_b64_tr_b16 v[40:41], v7 offset:29696
    ds_read_b64_tr_b16 v[42:43], v7 offset:29952
    s_waitcnt lgkmcnt(11)
    v_mfma_f32_16x16x32_bf16 v[12:15], v[44:47], v[16:19], v[12:15]
    v_mfma_f32_32x32x16_bf16 v[120:135], v[44:47], v[20:23], v[120:135]
    ds_read_b64_tr_b16 v[44:45], v7 offset:33792
    ds_read_b64_tr_b16 v[46:47], v7 offset:34048
    s_waitcnt lgkmcnt(11)
    v_mfma_f32_32x32x16_bf16 v[136:151], v[48:51], v[20:23], v[136:151]
    ds_read_b64_tr_b16 v[48:49], v7 offset:37888
    ds_read_b64_tr_b16 v[50:51], v7 offset:38144
    s_waitcnt lgkmcnt(10)
    v_mfma_f32_16x16x32_bf16 v[8:11], v[28:31], v[16:19], v[8:11]
    v_mfma_f32_32x32x16_bf16 v[56:71], v[28:31], v[24:27], v[56:71]
    ds_read_b128 v[20:23], v5
    ds_read_b64_tr_b16 v[28:29], v7 offset:18432
    ds_read_b64_tr_b16 v[30:31], v7 offset:18688
    s_waitcnt lgkmcnt(11)
    v_mfma_f32_32x32x16_bf16 v[72:87], v[32:35], v[24:27], v[72:87]
    ds_read_b64_tr_b16 v[32:33], v7 offset:22528
    ds_read_b64_tr_b16 v[34:35], v7 offset:22784
    s_waitcnt lgkmcnt(11)
    v_mfma_f32_32x32x16_bf16 v[88:103], v[24:27], v[36:39], v[88:103]
    ds_read_b64_tr_b16 v[36:37], v7 offset:26624
    ds_read_b64_tr_b16 v[38:39], v7 offset:26880
    s_waitcnt lgkmcnt(11)
    v_mfma_f32_32x32x16_bf16 v[104:119], v[40:43], v[24:27], v[104:119]
    ds_read_b64_tr_b16 v[40:41], v7 offset:30720
    ds_read_b64_tr_b16 v[42:43], v7 offset:30976
    s_waitcnt lgkmcnt(11)
    v_mfma_f32_16x16x32_bf16 v[12:15], v[44:47], v[16:19], v[12:15]
    v_mfma_f32_32x32x16_bf16 v[120:135], v[44:47], v[24:27], v[120:135]
    ds_read_b64_tr_b16 v[44:45], v7 offset:34816
    ds_read_b64_tr_b16 v[46:47], v7 offset:35072
    s_waitcnt lgkmcnt(11)
    v_mfma_f32_32x32x16_bf16 v[136:151], v[48:51], v[24:27], v[136:151]
    ds_read_b64_tr_b16 v[48:49], v7 offset:38912
    ds_read_b64_tr_b16 v[50:51], v7 offset:39168
    s_waitcnt lgkmcnt(10)
    v_mfma_f32_16x16x32_bf16 v[8:11], v[28:31], v[16:19], v[8:11]
    v_mfma_f32_32x32x16_bf16 v[56:71], v[28:31], v[20:23], v[56:71]
    ds_read_b128 v[24:27], v6
    ds_read_b64_tr_b16 v[28:29], v7 offset:19456
    ds_read_b64_tr_b16 v[30:31], v7 offset:19712
    s_waitcnt lgkmcnt(11)
    v_mfma_f32_32x32x16_bf16 v[72:87], v[32:35], v[20:23], v[72:87]
    ds_read_b64_tr_b16 v[32:33], v7 offset:23552
    ds_read_b64_tr_b16 v[34:35], v7 offset:23808
    s_waitcnt lgkmcnt(11)
    v_mfma_f32_32x32x16_bf16 v[88:103], v[20:23], v[36:39], v[88:103]
    ds_read_b64_tr_b16 v[36:37], v7 offset:27648
    ds_read_b64_tr_b16 v[38:39], v7 offset:27904
    s_waitcnt lgkmcnt(11)
    v_mfma_f32_32x32x16_bf16 v[104:119], v[40:43], v[20:23], v[104:119]
    ds_read_b64_tr_b16 v[40:41], v7 offset:31744
    ds_read_b64_tr_b16 v[42:43], v7 offset:32000
    s_waitcnt lgkmcnt(11)
    v_mfma_f32_16x16x32_bf16 v[12:15], v[44:47], v[16:19], v[12:15]
    v_mfma_f32_32x32x16_bf16 v[120:135], v[44:47], v[20:23], v[120:135]
    ds_read_b64_tr_b16 v[44:45], v7 offset:35840
    ds_read_b64_tr_b16 v[46:47], v7 offset:36096
    s_waitcnt lgkmcnt(11)
    v_mfma_f32_32x32x16_bf16 v[136:151], v[48:51], v[20:23], v[136:151]
    ds_read_b64_tr_b16 v[48:49], v7 offset:39936
    ds_read_b64_tr_b16 v[50:51], v7 offset:40192
    s_waitcnt lgkmcnt(10)
    v_mfma_f32_16x16x32_bf16 v[8:11], v[28:31], v[16:19], v[8:11]
    v_mfma_f32_32x32x16_bf16 v[56:71], v[28:31], v[24:27], v[56:71]
    s_cmp_eq_u32 s71, 2
    s_mov_b32 s54, 45056
    s_cmov_b32 s54, -90112
    v_add_u32 v3, s54, v3
    v_add_u32 v4, s54, v4
    v_add_u32 v7, s54, v7
    s_waitcnt lgkmcnt(8)
    v_mfma_f32_32x32x16_bf16 v[72:87], v[32:35], v[24:27], v[72:87]
    v_add_u32 v5, s54, v5
    v_add_u32 v6, s54, v6
    s_waitcnt lgkmcnt(6)
    v_mfma_f32_32x32x16_bf16 v[88:103], v[24:27], v[36:39], v[88:103]
    s_waitcnt lgkmcnt(0)
    s_barrier
    ds_read_b128 v[20:23], v3
    ds_read_b64_tr_b16 v[28:29], v7 offset:16384
    ds_read_b64_tr_b16 v[30:31], v7 offset:16640
    ds_read_b64_tr_b16 v[32:33], v7 offset:20480
    ds_read_b64_tr_b16 v[34:35], v7 offset:20736
    ds_read_b64_tr_b16 v[36:37], v7 offset:24576
    ds_read_b64_tr_b16 v[38:39], v7 offset:24832
    v_mfma_f32_32x32x16_bf16 v[104:119], v[40:43], v[24:27], v[104:119]
    ds_read_b64_tr_b16 v[40:41], v7 offset:28672
    ds_read_b64_tr_b16 v[42:43], v7 offset:28928
    v_mfma_f32_16x16x32_bf16 v[12:15], v[44:47], v[16:19], v[12:15]
    v_mfma_f32_32x32x16_bf16 v[120:135], v[44:47], v[24:27], v[120:135]
    ds_read_b64_tr_b16 v[44:45], v7 offset:32768
    ds_read_b64_tr_b16 v[46:47], v7 offset:33024
    v_mfma_f32_32x32x16_bf16 v[136:151], v[48:51], v[24:27], v[136:151]
    ds_read_b64_tr_b16 v[48:49], v7 offset:36864
    ds_read_b64_tr_b16 v[50:51], v7 offset:37120
    s_add_u32 s71, s71, 1
    s_cmp_eq_u32 s71, 3
    s_cselect_b32 s71, 0, s71
    s_add_u32 s26, s26, 1
    s_cmp_lt_u32 s26, 8
    s_cbranch_scc1 PB_L6_0
    s_branch PB_EPI
PB_L6_1:
    s_waitcnt lgkmcnt(10)
    v_mfma_f32_32x32x16_bf16 v[56:71], v[28:31], v[20:23], v[56:71]
    ds_read_b128 v[24:27], v4
    ds_read_b64_tr_b16 v[28:29], v7 offset:17408
    ds_read_b64_tr_b16 v[30:31], v7 offset:17664
    s_waitcnt lgkmcnt(11)
    v_mfma_f32_16x16x32_bf16 v[8:11], v[32:35], v[16:19], v[8:11]
    v_mfma_f32_32x32x16_bf16 v[72:87], v[32:35], v[20:23], v[72:87]
    ds_read_b64_tr_b16 v[32:33], v7 offset:21504
    ds_read_b64_tr_b16 v[34:35], v7 offset:21760
    s_waitcnt lgkmcnt(11)
    v_mfma_f32_32x32x16_bf16 v[88:103], v[20:23], v[36:39], v[88:103]
    ds_read_b64_tr_b16 v[36:37], v7 offset:25600
    ds_read_b64_tr_b16 v[38:39], v7 offset:25856
    s_waitcnt lgkmcnt(11)
    v_mfma_f32_32x32x16_bf16 v[104:119], v[40:43], v[20:23], v[104:119]
    ds_read_b64_tr_b16 v[40:41], v7 offset:29696
    ds_read_b64_tr_b16 v[42:43], v7 offset:29952
    s_waitcnt lgkmcnt(11)
    v_mfma_f32_32x32x16_bf16 v[120:135], v[44:47], v[20:23], v[120:135]
    ds_read_b64_tr_b16 v[44:45], v7 offset:33792
    ds_read_b64_tr_b16 v[46:47], v7 offset:34048
    s_waitcnt lgkmcnt(11)
    v_mfma_f32_16x16x32_bf16 v[12:15], v[48:51], v[16:19], v[12:15]
    v_mfma_f32_32x32x16_bf16 v[136:151], v[48:51], v[20:23], v[136:151]
    ds_read_b64_tr_b16 v[48:49], v7 offset:37888
    ds_read_b64_tr_b16 v[50:51], v7 offset:38144
    s_waitcnt lgkmcnt(10)
    v_mfma_f32_32x32x16_bf16 v[56:71], v[28:31], v[24:27], v[56:71]
    ds_read_b128 v[20:23], v5
    ds_read_b64_tr_b16 v[28:29], v7 offset:18432
    ds_read_b64_tr_b16 v[30:31], v7 offset:18688
    s_waitcnt lgkmcnt(11)
    v_mfma_f32_16x16x32_bf16 v[8:11], v[32:35], v[16:19], v[8:11]
    v_mfma_f32_32x32x16_bf16 v[72:87], v[32:35], v[24:27], v[72:87]
    ds_read_b64_tr_b16 v[32:33], v7 offset:22528
    ds_read_b64_tr_b16 v[34:35], v7 offset:22784
    s_waitcnt lgkmcnt(11)
    v_mfma_f32_32x32x16_bf16 v[88:103], v[24:27], v[36:39], v[88:103]
    ds_read_b64_tr_b16 v[36:37], v7 offset:26624
    ds_read_b64_tr_b16 v[38:39], v7 offset:26880
    s_waitcnt lgkmcnt(11)
    v_mfma_f32_32x32x16_bf16 v[104:119], v[40:43], v[24:27], v[104:119]
    ds_read_b64_tr_b16 v[40:41], v7 offset:30720
    ds_read_b64_tr_b16 v[42:43], v7 offset:30976
    s_waitcnt lgkmcnt(11)
    v_mfma_f32_32x32x16_bf16 v[120:135], v[44:47], v[24:27], v[120:135]
    ds_read_b64_tr_b16 v[44:45], v7 offset:34816
    ds_read_b64_tr_b16 v[46:47], v7 offset:35072
    s_waitcnt lgkmcnt(11)
    v_mfma_f32_16x16x32_bf16 v[12:15], v[48:51], v[16:19], v[12:15]
    v_mfma_f32_32x32x16_bf16 v[136:151], v[48:51], v[24:27], v[136:151]
    ds_read_b64_tr_b16 v[48:49], v7 offset:38912
    ds_read_b64_tr_b16 v[50:51], v7 offset:39168
    s_waitcnt lgkmcnt(10)
    v_mfma_f32_32x32x16_bf16 v[56:71], v[28:31], v[20:23], v[56:71]
    ds_read_b128 v[24:27], v6
    ds_read_b64_tr_b16 v[28:29], v7 offset:19456
    ds_read_b64_tr_b16 v[30:31], v7 offset:19712
    s_waitcnt lgkmcnt(11)
    v_mfma_f32_16x16x32_bf16 v[8:11], v[32:35], v[16:19], v[8:11]
    v_mfma_f32_32x32x16_bf16 v[72:87], v[32:35], v[20:23], v[72:87]
    ds_read_b64_tr_b16 v[32:33], v7 offset:23552
    ds_read_b64_tr_b16 v[34:35], v7 offset:23808
    s_waitcnt lgkmcnt(11)
    v_mfma_f32_32x32x16_bf16 v[88:103], v[20:23], v[36:39], v[88:103]
    ds_read_b64_tr_b16 v[36:37], v7 offset:27648
    ds_read_b64_tr_b16 v[38:39], v7 offset:27904
    s_waitcnt lgkmcnt(11)
    v_mfma_f32_32x32x16_bf16 v[104:119], v[40:43], v[20:23], v[104:119]
    ds_read_b64_tr_b16 v[40:41], v7 offset:31744
    ds_read_b64_tr_b16 v[42:43], v7 offset:32000
    s_waitcnt lgkmcnt(11)
    v_mfma_f32_32x32x16_bf16 v[120:135], v[44:47], v[20:23], v[120:135]
    ds_read_b64_tr_b16 v[44:45], v7 offset:35840
    ds_read_b64_tr_b16 v[46:47], v7 offset:36096
    s_waitcnt lgkmcnt(11)
    v_mfma_f32_16x16x32_bf16 v[12:15], v[48:51], v[16:19], v[12:15]
    v_mfma_f32_32x32x16_bf16 v[136:151], v[48:51], v[20:23], v[136:151]
    ds_read_b64_tr_b16 v[48:49], v7 offset:39936
    ds_read_b64_tr_b16 v[50:51], v7 offset:40192
    s_waitcnt lgkmcnt(10)
    v_mfma_f32_32x32x16_bf16 v[56:71], v[28:31], v[24:27], v[56:71]
    s_cmp_eq_u32 s71, 2
    s_mov_b32 s54, 45056
    s_cmov_b32 s54, -90112
    v_add_u32 v3, s54, v3
    v_add_u32 v4, s54, v4
    v_add_u32 v7, s54, v7
    s_waitcnt lgkmcnt(8)
    v_mfma_f32_16x16x32_bf16 v[8:11], v[32:35], v[16:19], v[8:11]
    v_mfma_f32_32x32x16_bf16 v[72:87], v[32:35], v[24:27], v[72:87]
    v_add_u32 v5, s54, v5
    v_add_u32 v6, s54, v6
    s_waitcnt lgkmcnt(6)
    v_mfma_f32_32x32x16_bf16 v[88:103], v[24:27], v[36:39], v[88:103]
    s_waitcnt lgkmcnt(0)
    s_barrier
    ds_read_b128 v[20:23], v3
    ds_read_b64_tr_b16 v[28:29], v7 offset:16384
    ds_read_b64_tr_b16 v[30:31], v7 offset:16640
    ds_read_b64_tr_b16 v[32:33], v7 offset:20480
    ds_read_b64_tr_b16 v[34:35], v7 offset:20736
    ds_read_b64_tr_b16 v[36:37], v7 offset:24576
    ds_read_b64_tr_b16 v[38:39], v7 offset:24832
    v_mfma_f32_32x32x16_bf16 v[104:119], v[40:43], v[24:27], v[104:119]
    ds_read_b64_tr_b16 v[40:41], v7 offset:28672
    ds_read_b64_tr_b16 v[42:43], v7 offset:28928
    v_mfma_f32_32x32x16_bf16 v[120:135], v[44:47], v[24:27], v[120:135]
    ds_read_b64_tr_b16 v[44:45], v7 offset:32768
    ds_read_b64_tr_b16 v[46:47], v7 offset:33024
    v_mfma_f32_16x16x32_bf16 v[12:15], v[48:51], v[16:19], v[12:15]
    v_mfma_f32_32x32x16_bf16 v[136:151], v[48:51], v[24:27], v[136:151]
    ds_read_b64_tr_b16 v[48:49], v7 offset:36864
    ds_read_b64_tr_b16 v[50:51], v7 offset:37120
    s_add_u32 s71, s71, 1
    s_cmp_eq_u32 s71, 3
    s_cselect_b32 s71, 0, s71
    s_add_u32 s26, s26, 1
    s_cmp_lt_u32 s26, 8
    s_cbranch_scc1 PB_L6_1
    s_branch PB_EPI
PB_L6_2:
    s_waitcnt lgkmcnt(10)
    v_mfma_f32_32x32x16_bf16 v[56:71], v[28:31], v[20:23], v[56:71]
    ds_read_b128 v[24:27], v4
    ds_read_b64_tr_b16 v[28:29], v7 offset:17408
    ds_read_b64_tr_b16 v[30:31], v7 offset:17664
    s_waitcnt lgkmcnt(11)
    v_mfma_f32_32x32x16_bf16 v[72:87], v[32:35], v[20:23], v[72:87]
    ds_read_b64_tr_b16 v[32:33], v7 offset:21504
    ds_read_b64_tr_b16 v[34:35], v7 offset:21760
    s_waitcnt lgkmcnt(11)
    v_mfma_f32_16x16x32_bf16 v[8:11], v[36:39], v[16:19], v[8:11]
    v_mfma_f32_32x32x16_bf16 v[88:103], v[20:23], v[36:39], v[88:103]
    ds_read_b64_tr_b16 v[36:37], v7 offset:25600
    ds_read_b64_tr_b16 v[38:39], v7 offset:25856
    s_waitcnt lgkmcnt(11)
    v_mfma_f32_32x32x16_bf16 v[104:119], v[40:43], v[20:23], v[104:119]
    ds_read_b64_tr_b16 v[40:41], v7 offset:29696
    ds_read_b64_tr_b16 v[42:43], v7 offset:29952
    s_waitcnt lgkmcnt(11)
    v_mfma_f32_32x32x16_bf16 v[120:135], v[44:47], v[20:23], v[120:135]
    ds_read_b64_tr_b16 v[44:45], v7 offset:33792
    ds_read_b64_tr_b16 v[46:47], v7 offset:34048
    s_waitcnt lgkmcnt(11)
    v_mfma_f32_32x32x16_bf16 v[136:151], v[48:51], v[20:23], v[136:151]
    ds_read_b64_tr_b16 v[48:49], v7 offset:37888
    ds_read_b64_tr_b16 v[50:51], v7 offset:38144
    s_waitcnt lgkmcnt(10)
    v_mfma_f32_32x32x16_bf16 v[56:71], v[28:31], v[24:27], v[56:71]
    ds_read_b128 v[20:23], v5
    ds_read_b64_tr_b16 v[28:29], v7 offset:18432
    ds_read_b64_tr_b16 v[30:31], v7 offset:18688
    s_waitcnt lgkmcnt(11)
    v_mfma_f32_32x32x16_bf16 v[72:87], v[32:35], v[24:27], v[72:87]
    ds_read_b64_tr_b16 v[32:33], v7 offset:22528
    ds_read_b64_tr_b16 v[34:35], v7 offset:22784
    s_waitcnt lgkmcnt(11)
    v_mfma_f32_16x16x32_bf16 v[8:11], v[36:39], v[16:19], v[8:11]
    v_mfma_f32_32x32x16_bf16 v[88:103], v[24:27], v[36:39], v[88:103]
    ds_read_b64_tr_b16 v[36:37], v7 offset:26624
    ds_read_b64_tr_b16 v[38:39], v7 offset:26880
    s_waitcnt lgkmcnt(11)
    v_mfma_f32_32x32x16_bf16 v[104:119], v[40:43], v[24:27], v[104:119]
    ds_read_b64_tr_b16 v[40:41], v7 offset:30720
    ds_read_b64_tr_b16 v[42:43], v7 offset:30976
    s_waitcnt lgkmcnt(11)
    v_mfma_f32_32x32x16_bf16 v[120:135], v[44:47], v[24:27], v[120:135]
    ds_read_b64_tr_b16 v[44:45], v7 offset:34816
    ds_read_b64_tr_b16 v[46:47], v7 offset:35072
    s_waitcnt lgkmcnt(11)
    v_mfma_f32_32x32x16_bf16 v[136:151], v[48:51], v[24:27], v[136:151]
    ds_read_b64_tr_b16 v[48:49], v7 offset:38912
    ds_read_b64_tr_b16 v[50:51], v7 offset:39168
    s_waitcnt lgkmcnt(10)
    v_mfma_f32_32x32x16_bf16 v[56:71], v[28:31], v[20:23], v[56:71]
    ds_read_b128 v[24:27], v6
    ds_read_b64_tr_b16 v[28:29], v7 offset:19456
    ds_read_b64_tr_b16 v[30:31], v7 offset:19712
    s_waitcnt lgkmcnt(11)
    v_mfma_f32_32x32x16_bf16 v[72:87], v[32:35], v[20:23], v[72:87]
    ds_read_b64_tr_b16 v[32:33], v7 offset:23552
    ds_read_b64_tr_b16 v[34:35], v7 offset:23808
    s_waitcnt lgkmcnt(11)
    v_mfma_f32_16x16x32_bf16 v[8:11], v[36:39], v[16:19], v[8:11]
    v_mfma_f32_32x32x16_bf16 v[88:103], v[20:23], v[36:39], v[88:103]
    ds_read_b64_tr_b16 v[36:37], v7 offset:27648
    ds_read_b64_tr_b16 v[38:39], v7 offset:27904
    s_waitcnt lgkmcnt(11)
    v_mfma_f32_32x32x16_bf16 v[104:119], v[40:43], v[20:23], v[104:119]
    ds_read_b64_tr_b16 v[40:41], v7 offset:31744
    ds_read_b64_tr_b16 v[42:43], v7 offset:32000
    s_waitcnt lgkmcnt(11)
    v_mfma_f32_32x32x16_bf16 v[120:135], v[44:47], v[20:23], v[120:135]
    ds_read_b64_tr_b16 v[44:45], v7 offset:35840
    ds_read_b64_tr_b16 v[46:47], v7 offset:36096
    s_waitcnt lgkmcnt(11)
    v_mfma_f32_32x32x16_bf16 v[136:151], v[48:51], v[20:23], v[136:151]
    ds_read_b64_tr_b16 v[48:49], v7 offset:39936
    ds_read_b64_tr_b16 v[50:51], v7 offset:40192
    s_waitcnt lgkmcnt(10)
    v_mfma_f32_32x32x16_bf16 v[56:71], v[28:31], v[24:27], v[56:71]
    s_cmp_eq_u32 s71, 2
    s_mov_b32 s54, 45056
    s_cmov_b32 s54, -90112
    v_add_u32 v3, s54, v3
    v_add_u32 v4, s54, v4
    v_add_u32 v7, s54, v7
    s_waitcnt lgkmcnt(8)
    v_mfma_f32_32x32x16_bf16 v[72:87], v[32:35], v[24:27], v[72:87]
    v_add_u32 v5, s54, v5
    v_add_u32 v6, s54, v6
    s_waitcnt lgkmcnt(6)
    v_mfma_f32_16x16x32_bf16 v[8:11], v[36:39], v[16:19], v[8:11]
    v_mfma_f32_32x32x16_bf16 v[88:103], v[24:27], v[36:39], v[88:103]
    s_waitcnt lgkmcnt(0)
    s_barrier
    ds_read_b128 v[20:23], v3
    ds_read_b64_tr_b16 v[28:29], v7 offset:16384
    ds_read_b64_tr_b16 v[30:31], v7 offset:16640
    ds_read_b64_tr_b16 v[32:33], v7 offset:20480
    ds_read_b64_tr_b16 v[34:35], v7 offset:20736
    ds_read_b64_tr_b16 v[36:37], v7 offset:24576
    ds_read_b64_tr_b16 v[38:39], v7 offset:24832
    v_mfma_f32_32x32x16_bf16 v[104:119], v[40:43], v[24:27], v[104:119]
    ds_read_b64_tr_b16 v[40:41], v7 offset:28672
    ds_read_b64_tr_b16 v[42:43], v7 offset:28928
    v_mfma_f32_32x32x16_bf16 v[120:135], v[44:47], v[24:27], v[120:135]
    ds_read_b64_tr_b16 v[44:45], v7 offset:32768
    ds_read_b64_tr_b16 v[46:47], v7 offset:33024
    v_mfma_f32_32x32x16_bf16 v[136:151], v[48:51], v[24:27], v[136:151]
    ds_read_b64_tr_b16 v[48:49], v7 offset:36864
    ds_read_b64_tr_b16 v[50:51], v7 offset:37120
    s_add_u32 s71, s71, 1
    s_cmp_eq_u32 s71, 3
    s_cselect_b32 s71, 0, s71
    s_add_u32 s26, s26, 1
    s_cmp_lt_u32 s26, 8
    s_cbranch_scc1 PB_L6_2
    s_branch PB_EPI
PB_L6_3:
    s_waitcnt lgkmcnt(10)
    v_mfma_f32_32x32x16_bf16 v[56:71], v[28:31], v[20:23], v[56:71]
    ds_read_b128 v[24:27], v4
    ds_read_b64_tr_b16 v[28:29], v7 offset:17408
    ds_read_b64_tr_b16 v[30:31], v7 offset:17664
    s_waitcnt lgkmcnt(11)
    v_mfma_f32_32x32x16_bf16 v[72:87], v[32:35], v[20:23], v[72:87]
    ds_read_b64_tr_b16 v[32:33], v7 offset:21504
    ds_read_b64_tr_b16 v[34:35], v7 offset:21760
    s_waitcnt lgkmcnt(11)
    v_mfma_f32_32x32x16_bf16 v[88:103], v[20:23], v[36:39], v[88:103]
    ds_read_b64_tr_b16 v[36:37], v7 offset:25600
    ds_read_b64_tr_b16 v[38:39], v7 offset:25856
    s_waitcnt lgkmcnt(11)
    v_mfma_f32_16x16x32_bf16 v[8:11], v[40:43], v[16:19], v[8:11]
    v_mfma_f32_32x32x16_bf16 v[104:119], v[40:43], v[20:23], v[104:119]
    ds_read_b64_tr_b16 v[40:41], v7 offset:29696
    ds_read_b64_tr_b16 v[42:43], v7 offset:29952
    s_waitcnt lgkmcnt(11)
    v_mfma_f32_32x32x16_bf16 v[120:135], v[44:47], v[20:23], v[120:135]
    ds_read_b64_tr_b16 v[44:45], v7 offset:33792
    ds_read_b64_tr_b16 v[46:47], v7 offset:34048
    s_waitcnt lgkmcnt(11)
    v_mfma_f32_32x32x16_bf16 v[136:151], v[48:51], v[20:23], v[136:151]
    ds_read_b64_tr_b16 v[48:49], v7 offset:37888
    ds_read_b64_tr_b16 v[50:51], v7 offset:38144
    s_waitcnt lgkmcnt(10)
    v_mfma_f32_32x32x16_bf16 v[56:71], v[28:31], v[24:27], v[56:71]
    ds_read_b128 v[20:23], v5
    ds_read_b64_tr_b16 v[28:29], v7 offset:18432
    ds_read_b64_tr_b16 v[30:31], v7 offset:18688
    s_waitcnt lgkmcnt(11)
    v_mfma_f32_32x32x16_bf16 v[72:87], v[32:35], v[24:27], v[72:87]
    ds_read_b64_tr_b16 v[32:33], v7 offset:22528
    ds_read_b64_tr_b16 v[34:35], v7 offset:22784
    s_waitcnt lgkmcnt(11)
    v_mfma_f32_32x32x16_bf16 v[88:103], v[24:27], v[36:39], v[88:103]
    ds_read_b64_tr_b16 v[36:37], v7 offset:26624
    ds_read_b64_tr_b16 v[38:39], v7 offset:26880
    s_waitcnt lgkmcnt(11)
    v_mfma_f32_16x16x32_bf16 v[8:11], v[40:43], v[16:19], v[8:11]
    v_mfma_f32_32x32x16_bf16 v[104:119], v[40:43], v[24:27], v[104:119]
    ds_read_b64_tr_b16 v[40:41], v7 offset:30720
    ds_read_b64_tr_b16 v[42:43], v7 offset:30976
    s_waitcnt lgkmcnt(11)
    v_mfma_f32_32x32x16_bf16 v[120:135], v[44:47], v[24:27], v[120:135]
    ds_read_b64_tr_b16 v[44:45], v7 offset:34816
    ds_read_b64_tr_b16 v[46:47], v7 offset:35072
    s_waitcnt lgkmcnt(11)
    v_mfma_f32_32x32x16_bf16 v[136:151], v[48:51], v[24:27], v[136:151]
    ds_read_b64_tr_b16 v[48:49], v7 offset:38912
    ds_read_b64_tr_b16 v[50:51], v7 offset:39168
    s_waitcnt lgkmcnt(10)
    v_mfma_f32_32x32x16_bf16 v[56:71], v[28:31], v[20:23], v[56:71]
    ds_read_b128 v[24:27], v6
    ds_read_b64_tr_b16 v[28:29], v7 offset:19456
    ds_read_b64_tr_b16 v[30:31], v7 offset:19712
    s_waitcnt lgkmcnt(11)
    v_mfma_f32_32x32x16_bf16 v[72:87], v[32:35], v[20:23], v[72:87]
    ds_read_b64_tr_b16 v[32:33], v7 offset:23552
    ds_read_b64_tr_b16 v[34:35], v7 offset:23808
    s_waitcnt lgkmcnt(11)
    v_mfma_f32_32x32x16_bf16 v[88:103], v[20:23], v[36:39], v[88:103]
    ds_read_b64_tr_b16 v[36:37], v7 offset:27648
    ds_read_b64_tr_b16 v[38:39], v7 offset:27904
    s_waitcnt lgkmcnt(11)
    v_mfma_f32_16x16x32_bf16 v[8:11], v[40:43], v[16:19], v[8:11]
    v_mfma_f32_32x32x16_bf16 v[104:119], v[40:43], v[20:23], v[104:119]
    ds_read_b64_tr_b16 v[40:41], v7 offset:31744
    ds_read_b64_tr_b16 v[42:43], v7 offset:32000
    s_waitcnt lgkmcnt(11)
    v_mfma_f32_32x32x16_bf16 v[120:135], v[44:47], v[20:23], v[120:135]
    ds_read_b64_tr_b16 v[44:45], v7 offset:35840
    ds_read_b64_tr_b16 v[46:47], v7 offset:36096
    s_waitcnt lgkmcnt(11)
    v_mfma_f32_32x32x16_bf16 v[136:151], v[48:51], v[20:23], v[136:151]
    ds_read_b64_tr_b16 v[48:49], v7 offset:39936
    ds_read_b64_tr_b16 v[50:51], v7 offset:40192
    s_waitcnt lgkmcnt(10)
    v_mfma_f32_32x32x16_bf16 v[56:71], v[28:31], v[24:27], v[56:71]
    s_cmp_eq_u32 s71, 2
    s_mov_b32 s54, 45056
    s_cmov_b32 s54, -90112
    v_add_u32 v3, s54, v3
    v_add_u32 v4, s54, v4
    v_add_u32 v7, s54, v7
    s_waitcnt lgkmcnt(8)
    v_mfma_f32_32x32x16_bf16 v[72:87], v[32:35], v[24:27], v[72:87]
    v_add_u32 v5, s54, v5
    v_add_u32 v6, s54, v6
    s_waitcnt lgkmcnt(6)
    v_mfma_f32_32x32x16_bf16 v[88:103], v[24:27], v[36:39], v[88:103]
    s_waitcnt lgkmcnt(0)
    s_barrier
    ds_read_b128 v[20:23], v3
    ds_read_b64_tr_b16 v[28:29], v7 offset:16384
    ds_read_b64_tr_b16 v[30:31], v7 offset:16640
    ds_read_b64_tr_b16 v[32:33], v7 offset:20480
    ds_read_b64_tr_b16 v[34:35], v7 offset:20736
    ds_read_b64_tr_b16 v[36:37], v7 offset:24576
    ds_read_b64_tr_b16 v[38:39], v7 offset:24832
    v_mfma_f32_16x16x32_bf16 v[8:11], v[40:43], v[16:19], v[8:11]
    v_mfma_f32_32x32x16_bf16 v[104:119], v[40:43], v[24:27], v[104:119]
    ds_read_b64_tr_b16 v[40:41], v7 offset:28672
    ds_read_b64_tr_b16 v[42:43], v7 offset:28928
    v_mfma_f32_32x32x16_bf16 v[120:135], v[44:47], v[24:27], v[120:135]
    ds_read_b64_tr_b16 v[44:45], v7 offset:32768
    ds_read_b64_tr_b16 v[46:47], v7 offset:33024
    v_mfma_f32_32x32x16_bf16 v[136:151], v[48:51], v[24:27], v[136:151]
    ds_read_b64_tr_b16 v[48:49], v7 offset:36864
    ds_read_b64_tr_b16 v[50:51], v7 offset:37120
    s_add_u32 s71, s71, 1
    s_cmp_eq_u32 s71, 3
    s_cselect_b32 s71, 0, s71
    s_add_u32 s26, s26, 1
    s_cmp_lt_u32 s26, 8
    s_cbranch_scc1 PB_L6_3
PB_EPI:
    s_lshl_b32 s54, s49, 7
    s_add_u32 s55, s54, 140416
    s_add_u32 s56, s54, 141056
    s_cmp_eq_u32 s49, 3
    s_cmov_b32 s55, 140928
    s_cmov_b32 s56, 140800
    v_and_b32 v16, 15, v1
    v_lshrrev_b32 v17, 4, v1
    v_lshlrev_b32 v18, 6, v16
    v_lshlrev_b32 v17, 4, v17
    v_add_u32 v17, v17, v18
    v_cmp_gt_u32 vcc, 2, v16
    v_add_u32 v18, s55, v17
    v_add_u32 v19, s56, v17
    s_mov_b64 exec, vcc
    ds_write_b128 v18, v[8:11]
    ds_write_b128 v19, v[12:15]
    s_mov_b64 exec, -1
    v_and_b32 v8, 31, v1
    v_lshrrev_b32 v11, 5, v1
    s_lshl_b32 s54, s49, 7
    v_lshlrev_b32 v18, 2, v8
    v_add_u32 v14, 140672, v18
    v_add_u32 v15, s54, v18
    v_lshlrev_b32 v19, 1, v15
    v_add_u32 v15, 141952, v15
    v_add_u32 v19, 142976, v19
    v_lshlrev_b32 v12, 4, v11
    v_add_u32 v13, s54, v12
    v_add_u32 v13, 141952, v13
    v_add_u32 v12, 140416, v12
    v_lshrrev_b32 v16, 4, v8
    v_lshlrev_b32 v16, 16, v16
    v_and_b32 v17, 15, v8
    v_lshlrev_b32 v17, 4, v17
    v_lshlrev_b32 v10, 8, v11
    v_add_u32 v10, v10, v16
    v_add_u32 v9, v10, v17
    s_waitcnt lgkmcnt(0)
    s_barrier
    ds_read_b32 v16, v15
    ds_read_b32 v17, v15 offset:512
    ds_read_b64 v[10:11], v19
    ds_read_b128 v[20:23], v12 offset:128
    ds_read_b128 v[24:27], v12 offset:160
    ds_read_b128 v[28:31], v12 offset:192
    ds_read_b128 v[32:35], v12 offset:224
    ds_read_b128 v[36:39], v12 offset:0
    ds_read_b128 v[40:43], v12 offset:32
    ds_read_b128 v[44:47], v12 offset:64
    ds_read_b128 v[48:51], v12 offset:96
    ds_read_b32 v52, v14
    s_lshl_b32 s62, s51, 17
    s_lshl_b32 s54, s53, 10
    s_add_u32 s62, s62, s54
    s_waitcnt lgkmcnt(5)
    v_mul_f32 v18, 0x3eb8aa3b, v16
    v_mul_f32 v19, 0x3eb8aa3b, v17
    v_pk_mul_f32 v[20:21], v[20:21], v[16:17] op_sel:[0,1] op_sel_hi:[1,1]
    v_pk_mul_f32 v[22:23], v[22:23], v[16:17] op_sel:[0,1] op_sel_hi:[1,1]
    v_pk_mul_f32 v[24:25], v[24:25], v[16:17] op_sel:[0,1] op_sel_hi:[1,1]
    v_pk_mul_f32 v[26:27], v[26:27], v[16:17] op_sel:[0,1] op_sel_hi:[1,1]
    v_pk_mul_f32 v[28:29], v[28:29], v[16:17] op_sel:[0,1] op_sel_hi:[1,1]
    v_pk_mul_f32 v[30:31], v[30:31], v[16:17] op_sel:[0,1] op_sel_hi:[1,1]
    v_pk_mul_f32 v[32:33], v[32:33], v[16:17] op_sel:[0,1] op_sel_hi:[1,1]
    v_pk_mul_f32 v[34:35], v[34:35], v[16:17] op_sel:[0,1] op_sel_hi:[1,1]
    v_pk_fma_f32 v[20:21], v[72:73], v[16:17], v[20:21] op_sel_hi:[1,0,1]
    v_pk_fma_f32 v[22:23], v[74:75], v[16:17], v[22:23] op_sel_hi:[1,0,1]
    v_pk_fma_f32 v[24:25], v[76:77], v[16:17], v[24:25] op_sel_hi:[1,0,1]
    v_pk_fma_f32 v[26:27], v[78:79], v[16:17], v[26:27] op_sel_hi:[1,0,1]
    v_pk_fma_f32 v[28:29], v[80:81], v[16:17], v[28:29] op_sel_hi:[1,0,1]
    v_pk_fma_f32 v[30:31], v[82:83], v[16:17], v[30:31] op_sel_hi:[1,0,1]
    v_pk_fma_f32 v[32:33], v[84:85], v[16:17], v[32:33] op_sel_hi:[1,0,1]
    v_pk_fma_f32 v[34:35], v[86:87], v[16:17], v[34:35] op_sel_hi:[1,0,1]
    v_cvt_pk_bf16_f32 v72, v20, v21
    v_cvt_pk_bf16_f32 v73, v22, v23
    v_cvt_pk_bf16_f32 v74, v24, v25
    v_cvt_pk_bf16_f32 v75, v26, v27
    v_cvt_pk_bf16_f32 v76, v28, v29
    v_cvt_pk_bf16_f32 v77, v30, v31
    v_cvt_pk_bf16_f32 v78, v32, v33
    v_cvt_pk_bf16_f32 v79, v34, v35
    ds_read_b128 v[20:23], v13 offset:0
    ds_read_b128 v[24:27], v13 offset:32
    ds_read_b128 v[28:31], v13 offset:64
    ds_read_b128 v[32:35], v13 offset:96
    s_add_u32 s54, s62, 2097152
    s_add_u32 s55, s62, 2162688
    buffer_store_dwordx4 v[72:75], v2, s[28:31], s54 offen sc1
    buffer_store_dwordx4 v[76:79], v2, s[28:31], s55 offen sc1
    s_waitcnt lgkmcnt(4)
    v_pk_mul_f32 v[36:37], v[36:37], v[18:19] op_sel:[0,1] op_sel_hi:[1,1]
    v_pk_mul_f32 v[38:39], v[38:39], v[18:19] op_sel:[0,1] op_sel_hi:[1,1]
    v_pk_mul_f32 v[40:41], v[40:41], v[18:19] op_sel:[0,1] op_sel_hi:[1,1]
    v_pk_mul_f32 v[42:43], v[42:43], v[18:19] op_sel:[0,1] op_sel_hi:[1,1]
    v_pk_mul_f32 v[44:45], v[44:45], v[18:19] op_sel:[0,1] op_sel_hi:[1,1]
    v_pk_mul_f32 v[46:47], v[46:47], v[18:19] op_sel:[0,1] op_sel_hi:[1,1]
    v_pk_mul_f32 v[48:49], v[48:49], v[18:19] op_sel:[0,1] op_sel_hi:[1,1]
    v_pk_mul_f32 v[50:51], v[50:51], v[18:19] op_sel:[0,1] op_sel_hi:[1,1]
    v_pk_fma_f32 v[36:37], v[56:57], v[18:19], v[36:37] op_sel_hi:[1,0,1]
    v_pk_fma_f32 v[38:39], v[58:59], v[18:19], v[38:39] op_sel_hi:[1,0,1]
    v_pk_fma_f32 v[40:41], v[60:61], v[18:19], v[40:41] op_sel_hi:[1,0,1]
    v_pk_fma_f32 v[42:43], v[62:63], v[18:19], v[42:43] op_sel_hi:[1,0,1]
    v_pk_fma_f32 v[44:45], v[64:65], v[18:19], v[44:45] op_sel_hi:[1,0,1]
    v_pk_fma_f32 v[46:47], v[66:67], v[18:19], v[46:47] op_sel_hi:[1,0,1]
    v_pk_fma_f32 v[48:49], v[68:69], v[18:19], v[48:49] op_sel_hi:[1,0,1]
    v_pk_fma_f32 v[50:51], v[70:71], v[18:19], v[50:51] op_sel_hi:[1,0,1]
    v_cvt_pk_bf16_f32 v56, v36, v37
    v_cvt_pk_bf16_f32 v57, v38, v39
    v_cvt_pk_bf16_f32 v58, v40, v41
    v_cvt_pk_bf16_f32 v59, v42, v43
    v_cvt_pk_bf16_f32 v60, v44, v45
    v_cvt_pk_bf16_f32 v61, v46, v47
    v_cvt_pk_bf16_f32 v62, v48, v49
    v_cvt_pk_bf16_f32 v63, v50, v51
    ds_read_b128 v[36:39], v13 offset:512
    ds_read_b128 v[40:43], v13 offset:544
    ds_read_b128 v[44:47], v13 offset:576
    ds_read_b128 v[48:51], v13 offset:608
    s_add_u32 s54, s62, 0
    s_add_u32 s55, s62, 65536
    buffer_store_dwordx4 v[56:59], v2, s[28:31], s54 offen sc1
    buffer_store_dwordx4 v[60:63], v2, s[28:31], s55 offen sc1
    s_waitcnt lgkmcnt(0)
    v_pk_mul_f32 v[36:37], v[36:37], v[52:53] op_sel_hi:[1,0]
    v_pk_mul_f32 v[38:39], v[38:39], v[52:53] op_sel_hi:[1,0]
    v_pk_mul_f32 v[40:41], v[40:41], v[52:53] op_sel_hi:[1,0]
    v_pk_mul_f32 v[42:43], v[42:43], v[52:53] op_sel_hi:[1,0]
    v_pk_mul_f32 v[44:45], v[44:45], v[52:53] op_sel_hi:[1,0]
    v_pk_mul_f32 v[46:47], v[46:47], v[52:53] op_sel_hi:[1,0]
    v_pk_mul_f32 v[48:49], v[48:49], v[52:53] op_sel_hi:[1,0]
    v_pk_mul_f32 v[50:51], v[50:51], v[52:53] op_sel_hi:[1,0]
    v_pk_fma_f32 v[36:37], v[88:89], v[20:21], v[36:37]
    v_pk_fma_f32 v[38:39], v[90:91], v[22:23], v[38:39]
    v_pk_fma_f32 v[40:41], v[92:93], v[24:25], v[40:41]
    v_pk_fma_f32 v[42:43], v[94:95], v[26:27], v[42:43]
    v_pk_fma_f32 v[44:45], v[96:97], v[28:29], v[44:45]
    v_pk_fma_f32 v[46:47], v[98:99], v[30:31], v[46:47]
    v_pk_fma_f32 v[48:49], v[100:101], v[32:33], v[48:49]
    v_pk_fma_f32 v[50:51], v[102:103], v[34:35], v[50:51]
    v_cvt_pk_bf16_f32 v88, v36, v37
    v_cvt_pk_bf16_f32 v89, v38, v39
    v_cvt_pk_bf16_f32 v90, v40, v41
    v_cvt_pk_bf16_f32 v91, v42, v43
    v_cvt_pk_bf16_f32 v92, v44, v45
    v_cvt_pk_bf16_f32 v93, v46, v47
    v_cvt_pk_bf16_f32 v94, v48, v49
    v_cvt_pk_bf16_f32 v95, v50, v51
    s_add_u32 s54, s62, 4194304
    buffer_store_dwordx4 v[88:91], v9, s[28:31], s54 offen sc1
    buffer_store_dwordx4 v[92:95], v9, s[28:31], s54 offen offset:512 sc1
    s_lshl_b32 s58, s51, 4
    s_add_u32 s58, s58, s50
    s_lshl_b32 s58, s58, 4
    s_add_u32 s58, s58, 14745600
    s_lshl_b32 s59, s50, 4
    s_add_u32 s59, s59, s51
    s_lshl_b32 s59, s59, 4
    s_add_u32 s59, s59, 14811136
    v_mov_b32 v20, 140288
    v_mov_b32 v21, 1
    v_mov_b32 v22, 0
    s_mov_b64 exec, 1
    ds_read_b32 v23, v20
    s_waitcnt vmcnt(0)
    ds_add_rtn_u32 v21, v20, v21 offset:12
    s_waitcnt lgkmcnt(0)
    v_readfirstlane_b32 s54, v21
    s_nop 1
    s_cmp_eq_u32 s54, 3
    s_cbranch_scc0 FZ_PQ0x
    buffer_store_dword v23, v22, s[28:31], s58 offen sc1
FZ_PQ0x:
    s_mov_b64 exec, -1
    s_bitcmp1_b32 s51, 0
    s_cbranch_scc1 PB_H3
    v_lshrrev_b32 v16, 5, v1
    v_lshlrev_b32 v16, 4, v16
    v_add_u32 v16, 140928, v16
    v_mov_b32 v12, 0xc0135761
    v_mov_b32 v14, 0xbdd2d3e8
    s_mul_i32 s62, s53, 114688
    s_lshl_b32 s54, s52, 11
    s_add_u32 s62, s62, s54
    s_add_u32 s62, s62, 16777216
    s_waitcnt lgkmcnt(0)
    s_nop 7
    ds_read_b128 v[24:27], v16 offset:0
    ds_read_b128 v[28:31], v16 offset:32
    ds_read_b128 v[32:35], v16 offset:64
    ds_read_b128 v[36:39], v16 offset:96
    ds_read_b128 v[40:43], v16 offset:512
    ds_read_b128 v[44:47], v16 offset:544
    ds_read_b128 v[48:51], v16 offset:576
    ds_read_b128 v[52:55], v16 offset:608
    s_waitcnt lgkmcnt(0)
    ds_read_b128 v[56:59], v16 offset:128
    ds_read_b128 v[60:63], v16 offset:160
    ds_read_b128 v[64:67], v16 offset:192
    ds_read_b128 v[68:71], v16 offset:224
    ds_read_b128 v[72:75], v16 offset:640
    ds_read_b128 v[76:79], v16 offset:672
    ds_read_b128 v[80:83], v16 offset:704
    ds_read_b128 v[84:87], v16 offset:736
    v_pk_fma_f32 v[88:89], v[24:25], v[10:11], v[40:41] op_sel:[0,1,0] op_sel_hi:[1,1,1]
    v_pk_fma_f32 v[92:93], v[26:27], v[10:11], v[42:43] op_sel:[0,1,0] op_sel_hi:[1,1,1]
    v_pk_fma_f32 v[96:97], v[28:29], v[10:11], v[44:45] op_sel:[0,1,0] op_sel_hi:[1,1,1]
    v_pk_fma_f32 v[100:101], v[30:31], v[10:11], v[46:47] op_sel:[0,1,0] op_sel_hi:[1,1,1]
    v_pk_fma_f32 v[88:89], v[104:105], v[10:11], v[88:89] op_sel_hi:[1,0,1]
    v_pk_fma_f32 v[92:93], v[106:107], v[10:11], v[92:93] op_sel_hi:[1,0,1]
    v_pk_fma_f32 v[96:97], v[108:109], v[10:11], v[96:97] op_sel_hi:[1,0,1]
    v_pk_fma_f32 v[100:101], v[110:111], v[10:11], v[100:101] op_sel_hi:[1,0,1]
    v_pk_mul_f32 v[90:91], v[88:89], v[88:89]
    v_pk_mul_f32 v[94:95], v[92:93], v[92:93]
    v_pk_mul_f32 v[98:99], v[96:97], v[96:97]
    v_pk_mul_f32 v[102:103], v[100:101], v[100:101]
    v_pk_fma_f32 v[90:91], v[90:91], v[14:15], v[12:13] op_sel_hi:[1,0,0]
    v_pk_fma_f32 v[94:95], v[94:95], v[14:15], v[12:13] op_sel_hi:[1,0,0]
    v_pk_fma_f32 v[98:99], v[98:99], v[14:15], v[12:13] op_sel_hi:[1,0,0]
    v_pk_fma_f32 v[102:103], v[102:103], v[14:15], v[12:13] op_sel_hi:[1,0,0]
    v_pk_mul_f32 v[90:91], v[90:91], v[88:89]
    v_pk_mul_f32 v[94:95], v[94:95], v[92:93]
    v_pk_mul_f32 v[98:99], v[98:99], v[96:97]
    v_pk_mul_f32 v[102:103], v[102:103], v[100:101]
    v_exp_f32 v90, v90
    v_exp_f32 v91, v91
    v_exp_f32 v94, v94
    v_exp_f32 v95, v95
    v_exp_f32 v98, v98
    v_exp_f32 v99, v99
    v_exp_f32 v102, v102
    v_exp_f32 v103, v103
    v_pk_add_f32 v[90:91], v[90:91], 1.0 op_sel_hi:[1,0]
    v_pk_add_f32 v[94:95], v[94:95], 1.0 op_sel_hi:[1,0]
    v_pk_add_f32 v[98:99], v[98:99], 1.0 op_sel_hi:[1,0]
    v_pk_add_f32 v[102:103], v[102:103], 1.0 op_sel_hi:[1,0]
    v_rcp_f32 v90, v90
    v_rcp_f32 v91, v91
    v_rcp_f32 v94, v94
    v_rcp_f32 v95, v95
    v_rcp_f32 v98, v98
    v_rcp_f32 v99, v99
    v_rcp_f32 v102, v102
    v_rcp_f32 v103, v103
    v_pk_mul_f32 v[88:89], v[88:89], v[90:91]
    v_pk_mul_f32 v[92:93], v[92:93], v[94:95]
    v_pk_mul_f32 v[96:97], v[96:97], v[98:99]
    v_pk_mul_f32 v[100:101], v[100:101], v[102:103]
    v_cvt_pk_bf16_f32 v104, v88, v89
    v_cvt_pk_bf16_f32 v105, v92, v93
    v_cvt_pk_bf16_f32 v106, v96, v97
    v_cvt_pk_bf16_f32 v107, v100, v101
    v_pk_fma_f32 v[88:89], v[32:33], v[10:11], v[48:49] op_sel:[0,1,0] op_sel_hi:[1,1,1]
    v_pk_fma_f32 v[92:93], v[34:35], v[10:11], v[50:51] op_sel:[0,1,0] op_sel_hi:[1,1,1]
    v_pk_fma_f32 v[96:97], v[36:37], v[10:11], v[52:53] op_sel:[0,1,0] op_sel_hi:[1,1,1]
    v_pk_fma_f32 v[100:101], v[38:39], v[10:11], v[54:55] op_sel:[0,1,0] op_sel_hi:[1,1,1]
    v_pk_fma_f32 v[88:89], v[112:113], v[10:11], v[88:89] op_sel_hi:[1,0,1]
    v_pk_fma_f32 v[92:93], v[114:115], v[10:11], v[92:93] op_sel_hi:[1,0,1]
    v_pk_fma_f32 v[96:97], v[116:117], v[10:11], v[96:97] op_sel_hi:[1,0,1]
    v_pk_fma_f32 v[100:101], v[118:119], v[10:11], v[100:101] op_sel_hi:[1,0,1]
    v_pk_mul_f32 v[90:91], v[88:89], v[88:89]
    v_pk_mul_f32 v[94:95], v[92:93], v[92:93]
    v_pk_mul_f32 v[98:99], v[96:97], v[96:97]
    v_pk_mul_f32 v[102:103], v[100:101], v[100:101]
    v_pk_fma_f32 v[90:91], v[90:91], v[14:15], v[12:13] op_sel_hi:[1,0,0]
    v_pk_fma_f32 v[94:95], v[94:95], v[14:15], v[12:13] op_sel_hi:[1,0,0]
    v_pk_fma_f32 v[98:99], v[98:99], v[14:15], v[12:13] op_sel_hi:[1,0,0]
    v_pk_fma_f32 v[102:103], v[102:103], v[14:15], v[12:13] op_sel_hi:[1,0,0]
    v_pk_mul_f32 v[90:91], v[90:91], v[88:89]
    v_pk_mul_f32 v[94:95], v[94:95], v[92:93]
    v_pk_mul_f32 v[98:99], v[98:99], v[96:97]
    v_pk_mul_f32 v[102:103], v[102:103], v[100:101]
    v_exp_f32 v90, v90
    v_exp_f32 v91, v91
    v_exp_f32 v94, v94
    v_exp_f32 v95, v95
    v_exp_f32 v98, v98
    v_exp_f32 v99, v99
    v_exp_f32 v102, v102
    v_exp_f32 v103, v103
    v_pk_add_f32 v[90:91], v[90:91], 1.0 op_sel_hi:[1,0]
    v_pk_add_f32 v[94:95], v[94:95], 1.0 op_sel_hi:[1,0]
    v_pk_add_f32 v[98:99], v[98:99], 1.0 op_sel_hi:[1,0]
    v_pk_add_f32 v[102:103], v[102:103], 1.0 op_sel_hi:[1,0]
    v_rcp_f32 v90, v90
    v_rcp_f32 v91, v91
    v_rcp_f32 v94, v94
    v_rcp_f32 v95, v95
    v_rcp_f32 v98, v98
    v_rcp_f32 v99, v99
    v_rcp_f32 v102, v102
    v_rcp_f32 v103, v103
    v_pk_mul_f32 v[88:89], v[88:89], v[90:91]
    v_pk_mul_f32 v[92:93], v[92:93], v[94:95]
    v_pk_mul_f32 v[96:97], v[96:97], v[98:99]
    v_pk_mul_f32 v[100:101], v[100:101], v[102:103]
    v_cvt_pk_bf16_f32 v108, v88, v89
    v_cvt_pk_bf16_f32 v109, v92, v93
    v_cvt_pk_bf16_f32 v110, v96, v97
    v_cvt_pk_bf16_f32 v111, v100, v101
    s_waitcnt lgkmcnt(0)
    ds_read_b128 v[24:27], v16 offset:256
    ds_read_b128 v[28:31], v16 offset:288
    ds_read_b128 v[32:35], v16 offset:320
    ds_read_b128 v[36:39], v16 offset:352
    ds_read_b128 v[40:43], v16 offset:768
    ds_read_b128 v[44:47], v16 offset:800
    ds_read_b128 v[48:51], v16 offset:832
    ds_read_b128 v[52:55], v16 offset:864
    v_pk_fma_f32 v[88:89], v[56:57], v[10:11], v[72:73] op_sel:[0,1,0] op_sel_hi:[1,1,1]
    v_pk_fma_f32 v[92:93], v[58:59], v[10:11], v[74:75] op_sel:[0,1,0] op_sel_hi:[1,1,1]
    v_pk_fma_f32 v[96:97], v[60:61], v[10:11], v[76:77] op_sel:[0,1,0] op_sel_hi:[1,1,1]
    v_pk_fma_f32 v[100:101], v[62:63], v[10:11], v[78:79] op_sel:[0,1,0] op_sel_hi:[1,1,1]
    v_pk_fma_f32 v[88:89], v[120:121], v[10:11], v[88:89] op_sel_hi:[1,0,1]
    v_pk_fma_f32 v[92:93], v[122:123], v[10:11], v[92:93] op_sel_hi:[1,0,1]
    v_pk_fma_f32 v[96:97], v[124:125], v[10:11], v[96:97] op_sel_hi:[1,0,1]
    v_pk_fma_f32 v[100:101], v[126:127], v[10:11], v[100:101] op_sel_hi:[1,0,1]
    v_pk_mul_f32 v[90:91], v[88:89], v[88:89]
    v_pk_mul_f32 v[94:95], v[92:93], v[92:93]
    v_pk_mul_f32 v[98:99], v[96:97], v[96:97]
    v_pk_mul_f32 v[102:103], v[100:101], v[100:101]
    v_pk_fma_f32 v[90:91], v[90:91], v[14:15], v[12:13] op_sel_hi:[1,0,0]
    v_pk_fma_f32 v[94:95], v[94:95], v[14:15], v[12:13] op_sel_hi:[1,0,0]
    v_pk_fma_f32 v[98:99], v[98:99], v[14:15], v[12:13] op_sel_hi:[1,0,0]
    v_pk_fma_f32 v[102:103], v[102:103], v[14:15], v[12:13] op_sel_hi:[1,0,0]
    v_pk_mul_f32 v[90:91], v[90:91], v[88:89]
    v_pk_mul_f32 v[94:95], v[94:95], v[92:93]
    v_pk_mul_f32 v[98:99], v[98:99], v[96:97]
    v_pk_mul_f32 v[102:103], v[102:103], v[100:101]
    v_exp_f32 v90, v90
    v_exp_f32 v91, v91
    v_exp_f32 v94, v94
    v_exp_f32 v95, v95
    v_exp_f32 v98, v98
    v_exp_f32 v99, v99
    v_exp_f32 v102, v102
    v_exp_f32 v103, v103
    v_pk_add_f32 v[90:91], v[90:91], 1.0 op_sel_hi:[1,0]
    v_pk_add_f32 v[94:95], v[94:95], 1.0 op_sel_hi:[1,0]
    v_pk_add_f32 v[98:99], v[98:99], 1.0 op_sel_hi:[1,0]
    v_pk_add_f32 v[102:103], v[102:103], 1.0 op_sel_hi:[1,0]
    v_rcp_f32 v90, v90
    v_rcp_f32 v91, v91
    v_rcp_f32 v94, v94
    v_rcp_f32 v95, v95
    v_rcp_f32 v98, v98
    v_rcp_f32 v99, v99
    v_rcp_f32 v102, v102
    v_rcp_f32 v103, v103
    v_pk_mul_f32 v[88:89], v[88:89], v[90:91]
    v_pk_mul_f32 v[92:93], v[92:93], v[94:95]
    v_pk_mul_f32 v[96:97], v[96:97], v[98:99]
    v_pk_mul_f32 v[100:101], v[100:101], v[102:103]
    v_cvt_pk_bf16_f32 v120, v88, v89
    v_cvt_pk_bf16_f32 v121, v92, v93
    v_cvt_pk_bf16_f32 v122, v96, v97
    v_cvt_pk_bf16_f32 v123, v100, v101
    v_pk_fma_f32 v[88:89], v[64:65], v[10:11], v[80:81] op_sel:[0,1,0] op_sel_hi:[1,1,1]
    v_pk_fma_f32 v[92:93], v[66:67], v[10:11], v[82:83] op_sel:[0,1,0] op_sel_hi:[1,1,1]
    v_pk_fma_f32 v[96:97], v[68:69], v[10:11], v[84:85] op_sel:[0,1,0] op_sel_hi:[1,1,1]
    v_pk_fma_f32 v[100:101], v[70:71], v[10:11], v[86:87] op_sel:[0,1,0] op_sel_hi:[1,1,1]
    v_pk_fma_f32 v[88:89], v[128:129], v[10:11], v[88:89] op_sel_hi:[1,0,1]
    v_pk_fma_f32 v[92:93], v[130:131], v[10:11], v[92:93] op_sel_hi:[1,0,1]
    v_pk_fma_f32 v[96:97], v[132:133], v[10:11], v[96:97] op_sel_hi:[1,0,1]
    v_pk_fma_f32 v[100:101], v[134:135], v[10:11], v[100:101] op_sel_hi:[1,0,1]
    v_pk_mul_f32 v[90:91], v[88:89], v[88:89]
    v_pk_mul_f32 v[94:95], v[92:93], v[92:93]
    v_pk_mul_f32 v[98:99], v[96:97], v[96:97]
    v_pk_mul_f32 v[102:103], v[100:101], v[100:101]
    v_pk_fma_f32 v[90:91], v[90:91], v[14:15], v[12:13] op_sel_hi:[1,0,0]
    v_pk_fma_f32 v[94:95], v[94:95], v[14:15], v[12:13] op_sel_hi:[1,0,0]
    v_pk_fma_f32 v[98:99], v[98:99], v[14:15], v[12:13] op_sel_hi:[1,0,0]
    v_pk_fma_f32 v[102:103], v[102:103], v[14:15], v[12:13] op_sel_hi:[1,0,0]
    v_pk_mul_f32 v[90:91], v[90:91], v[88:89]
    v_pk_mul_f32 v[94:95], v[94:95], v[92:93]
    v_pk_mul_f32 v[98:99], v[98:99], v[96:97]
    v_pk_mul_f32 v[102:103], v[102:103], v[100:101]
    v_exp_f32 v90, v90
    v_exp_f32 v91, v91
    v_exp_f32 v94, v94
    v_exp_f32 v95, v95
    v_exp_f32 v98, v98
    v_exp_f32 v99, v99
    v_exp_f32 v102, v102
    v_exp_f32 v103, v103
    v_pk_add_f32 v[90:91], v[90:91], 1.0 op_sel_hi:[1,0]
    v_pk_add_f32 v[94:95], v[94:95], 1.0 op_sel_hi:[1,0]
    v_pk_add_f32 v[98:99], v[98:99], 1.0 op_sel_hi:[1,0]
    v_pk_add_f32 v[102:103], v[102:103], 1.0 op_sel_hi:[1,0]
    v_rcp_f32 v90, v90
    v_rcp_f32 v91, v91
    v_rcp_f32 v94, v94
    v_rcp_f32 v95, v95
    v_rcp_f32 v98, v98
    v_rcp_f32 v99, v99
    v_rcp_f32 v102, v102
    v_rcp_f32 v103, v103
    v_pk_mul_f32 v[88:89], v[88:89], v[90:91]
    v_pk_mul_f32 v[92:93], v[92:93], v[94:95]
    v_pk_mul_f32 v[96:97], v[96:97], v[98:99]
    v_pk_mul_f32 v[100:101], v[100:101], v[102:103]
    v_cvt_pk_bf16_f32 v124, v88, v89
    v_cvt_pk_bf16_f32 v125, v92, v93
    v_cvt_pk_bf16_f32 v126, v96, v97
    v_cvt_pk_bf16_f32 v127, v100, v101
    s_waitcnt lgkmcnt(0)
    ds_read_b128 v[56:59], v16 offset:384
    ds_read_b128 v[60:63], v16 offset:416
    ds_read_b128 v[64:67], v16 offset:448
    ds_read_b128 v[68:71], v16 offset:480
    ds_read_b128 v[72:75], v16 offset:896
    ds_read_b128 v[76:79], v16 offset:928
    ds_read_b128 v[80:83], v16 offset:960
    ds_read_b128 v[84:87], v16 offset:992
    v_pk_fma_f32 v[88:89], v[24:25], v[10:11], v[40:41] op_sel:[0,1,0] op_sel_hi:[1,1,1]
    v_pk_fma_f32 v[92:93], v[26:27], v[10:11], v[42:43] op_sel:[0,1,0] op_sel_hi:[1,1,1]
    v_pk_fma_f32 v[96:97], v[28:29], v[10:11], v[44:45] op_sel:[0,1,0] op_sel_hi:[1,1,1]
    v_pk_fma_f32 v[100:101], v[30:31], v[10:11], v[46:47] op_sel:[0,1,0] op_sel_hi:[1,1,1]
    v_pk_fma_f32 v[88:89], v[136:137], v[10:11], v[88:89] op_sel_hi:[1,0,1]
    v_pk_fma_f32 v[92:93], v[138:139], v[10:11], v[92:93] op_sel_hi:[1,0,1]
    v_pk_fma_f32 v[96:97], v[140:141], v[10:11], v[96:97] op_sel_hi:[1,0,1]
    v_pk_fma_f32 v[100:101], v[142:143], v[10:11], v[100:101] op_sel_hi:[1,0,1]
    v_pk_mul_f32 v[90:91], v[88:89], v[88:89]
    v_pk_mul_f32 v[94:95], v[92:93], v[92:93]
    v_pk_mul_f32 v[98:99], v[96:97], v[96:97]
    v_pk_mul_f32 v[102:103], v[100:101], v[100:101]
    v_pk_fma_f32 v[90:91], v[90:91], v[14:15], v[12:13] op_sel_hi:[1,0,0]
    v_pk_fma_f32 v[94:95], v[94:95], v[14:15], v[12:13] op_sel_hi:[1,0,0]
    v_pk_fma_f32 v[98:99], v[98:99], v[14:15], v[12:13] op_sel_hi:[1,0,0]
    v_pk_fma_f32 v[102:103], v[102:103], v[14:15], v[12:13] op_sel_hi:[1,0,0]
    v_pk_mul_f32 v[90:91], v[90:91], v[88:89]
    v_pk_mul_f32 v[94:95], v[94:95], v[92:93]
    v_pk_mul_f32 v[98:99], v[98:99], v[96:97]
    v_pk_mul_f32 v[102:103], v[102:103], v[100:101]
    v_exp_f32 v90, v90
    v_exp_f32 v91, v91
    v_exp_f32 v94, v94
    v_exp_f32 v95, v95
    v_exp_f32 v98, v98
    v_exp_f32 v99, v99
    v_exp_f32 v102, v102
    v_exp_f32 v103, v103
    v_pk_add_f32 v[90:91], v[90:91], 1.0 op_sel_hi:[1,0]
    v_pk_add_f32 v[94:95], v[94:95], 1.0 op_sel_hi:[1,0]
    v_pk_add_f32 v[98:99], v[98:99], 1.0 op_sel_hi:[1,0]
    v_pk_add_f32 v[102:103], v[102:103], 1.0 op_sel_hi:[1,0]
    v_rcp_f32 v90, v90
    v_rcp_f32 v91, v91
    v_rcp_f32 v94, v94
    v_rcp_f32 v95, v95
    v_rcp_f32 v98, v98
    v_rcp_f32 v99, v99
    v_rcp_f32 v102, v102
    v_rcp_f32 v103, v103
    v_pk_mul_f32 v[88:89], v[88:89], v[90:91]
    v_pk_mul_f32 v[92:93], v[92:93], v[94:95]
    v_pk_mul_f32 v[96:97], v[96:97], v[98:99]
    v_pk_mul_f32 v[100:101], v[100:101], v[102:103]
    v_cvt_pk_bf16_f32 v136, v88, v89
    v_cvt_pk_bf16_f32 v137, v92, v93
    v_cvt_pk_bf16_f32 v138, v96, v97
    v_cvt_pk_bf16_f32 v139, v100, v101
    v_pk_fma_f32 v[88:89], v[32:33], v[10:11], v[48:49] op_sel:[0,1,0] op_sel_hi:[1,1,1]
    v_pk_fma_f32 v[92:93], v[34:35], v[10:11], v[50:51] op_sel:[0,1,0] op_sel_hi:[1,1,1]
    v_pk_fma_f32 v[96:97], v[36:37], v[10:11], v[52:53] op_sel:[0,1,0] op_sel_hi:[1,1,1]
    v_pk_fma_f32 v[100:101], v[38:39], v[10:11], v[54:55] op_sel:[0,1,0] op_sel_hi:[1,1,1]
    v_pk_fma_f32 v[88:89], v[144:145], v[10:11], v[88:89] op_sel_hi:[1,0,1]
    v_pk_fma_f32 v[92:93], v[146:147], v[10:11], v[92:93] op_sel_hi:[1,0,1]
    v_pk_fma_f32 v[96:97], v[148:149], v[10:11], v[96:97] op_sel_hi:[1,0,1]
    v_pk_fma_f32 v[100:101], v[150:151], v[10:11], v[100:101] op_sel_hi:[1,0,1]
    v_pk_mul_f32 v[90:91], v[88:89], v[88:89]
    v_pk_mul_f32 v[94:95], v[92:93], v[92:93]
    v_pk_mul_f32 v[98:99], v[96:97], v[96:97]
    v_pk_mul_f32 v[102:103], v[100:101], v[100:101]
    v_pk_fma_f32 v[90:91], v[90:91], v[14:15], v[12:13] op_sel_hi:[1,0,0]
    v_pk_fma_f32 v[94:95], v[94:95], v[14:15], v[12:13] op_sel_hi:[1,0,0]
    v_pk_fma_f32 v[98:99], v[98:99], v[14:15], v[12:13] op_sel_hi:[1,0,0]
    v_pk_fma_f32 v[102:103], v[102:103], v[14:15], v[12:13] op_sel_hi:[1,0,0]
    v_pk_mul_f32 v[90:91], v[90:91], v[88:89]
    v_pk_mul_f32 v[94:95], v[94:95], v[92:93]
    v_pk_mul_f32 v[98:99], v[98:99], v[96:97]
    v_pk_mul_f32 v[102:103], v[102:103], v[100:101]
    v_exp_f32 v90, v90
    v_exp_f32 v91, v91
    v_exp_f32 v94, v94
    v_exp_f32 v95, v95
    v_exp_f32 v98, v98
    v_exp_f32 v99, v99
    v_exp_f32 v102, v102
    v_exp_f32 v103, v103
    v_pk_add_f32 v[90:91], v[90:91], 1.0 op_sel_hi:[1,0]
    v_pk_add_f32 v[94:95], v[94:95], 1.0 op_sel_hi:[1,0]
    v_pk_add_f32 v[98:99], v[98:99], 1.0 op_sel_hi:[1,0]
    v_pk_add_f32 v[102:103], v[102:103], 1.0 op_sel_hi:[1,0]
    v_rcp_f32 v90, v90
    v_rcp_f32 v91, v91
    v_rcp_f32 v94, v94
    v_rcp_f32 v95, v95
    v_rcp_f32 v98, v98
    v_rcp_f32 v99, v99
    v_rcp_f32 v102, v102
    v_rcp_f32 v103, v103
    v_pk_mul_f32 v[88:89], v[88:89], v[90:91]
    v_pk_mul_f32 v[92:93], v[92:93], v[94:95]
    v_pk_mul_f32 v[96:97], v[96:97], v[98:99]
    v_pk_mul_f32 v[100:101], v[100:101], v[102:103]
    v_cvt_pk_bf16_f32 v140, v88, v89
    v_cvt_pk_bf16_f32 v141, v92, v93
    v_cvt_pk_bf16_f32 v142, v96, v97
    v_cvt_pk_bf16_f32 v143, v100, v101
    s_waitcnt lgkmcnt(0)
    v_pk_fma_f32 v[88:89], v[56:57], v[10:11], v[72:73] op_sel:[0,1,0] op_sel_hi:[1,1,1]
    v_pk_fma_f32 v[92:93], v[58:59], v[10:11], v[74:75] op_sel:[0,1,0] op_sel_hi:[1,1,1]
    v_pk_fma_f32 v[96:97], v[60:61], v[10:11], v[76:77] op_sel:[0,1,0] op_sel_hi:[1,1,1]
    v_pk_fma_f32 v[100:101], v[62:63], v[10:11], v[78:79] op_sel:[0,1,0] op_sel_hi:[1,1,1]
    v_pk_fma_f32 v[88:89], v[152:153], v[10:11], v[88:89] op_sel_hi:[1,0,1]
    v_pk_fma_f32 v[92:93], v[154:155], v[10:11], v[92:93] op_sel_hi:[1,0,1]
    v_pk_fma_f32 v[96:97], v[156:157], v[10:11], v[96:97] op_sel_hi:[1,0,1]
    v_pk_fma_f32 v[100:101], v[158:159], v[10:11], v[100:101] op_sel_hi:[1,0,1]
    v_pk_mul_f32 v[90:91], v[88:89], v[88:89]
    v_pk_mul_f32 v[94:95], v[92:93], v[92:93]
    v_pk_mul_f32 v[98:99], v[96:97], v[96:97]
    v_pk_mul_f32 v[102:103], v[100:101], v[100:101]
    v_pk_fma_f32 v[90:91], v[90:91], v[14:15], v[12:13] op_sel_hi:[1,0,0]
    v_pk_fma_f32 v[94:95], v[94:95], v[14:15], v[12:13] op_sel_hi:[1,0,0]
    v_pk_fma_f32 v[98:99], v[98:99], v[14:15], v[12:13] op_sel_hi:[1,0,0]
    v_pk_fma_f32 v[102:103], v[102:103], v[14:15], v[12:13] op_sel_hi:[1,0,0]
    v_pk_mul_f32 v[90:91], v[90:91], v[88:89]
    v_pk_mul_f32 v[94:95], v[94:95], v[92:93]
    v_pk_mul_f32 v[98:99], v[98:99], v[96:97]
    v_pk_mul_f32 v[102:103], v[102:103], v[100:101]
    v_exp_f32 v90, v90
    v_exp_f32 v91, v91
    v_exp_f32 v94, v94
    v_exp_f32 v95, v95
    v_exp_f32 v98, v98
    v_exp_f32 v99, v99
    v_exp_f32 v102, v102
    v_exp_f32 v103, v103
    v_pk_add_f32 v[90:91], v[90:91], 1.0 op_sel_hi:[1,0]
    v_pk_add_f32 v[94:95], v[94:95], 1.0 op_sel_hi:[1,0]
    v_pk_add_f32 v[98:99], v[98:99], 1.0 op_sel_hi:[1,0]
    v_pk_add_f32 v[102:103], v[102:103], 1.0 op_sel_hi:[1,0]
    v_rcp_f32 v90, v90
    v_rcp_f32 v91, v91
    v_rcp_f32 v94, v94
    v_rcp_f32 v95, v95
    v_rcp_f32 v98, v98
    v_rcp_f32 v99, v99
    v_rcp_f32 v102, v102
    v_rcp_f32 v103, v103
    v_pk_mul_f32 v[88:89], v[88:89], v[90:91]
    v_pk_mul_f32 v[92:93], v[92:93], v[94:95]
    v_pk_mul_f32 v[96:97], v[96:97], v[98:99]
    v_pk_mul_f32 v[100:101], v[100:101], v[102:103]
    v_cvt_pk_bf16_f32 v152, v88, v89
    v_cvt_pk_bf16_f32 v153, v92, v93
    v_cvt_pk_bf16_f32 v154, v96, v97
    v_cvt_pk_bf16_f32 v155, v100, v101
    v_pk_fma_f32 v[88:89], v[64:65], v[10:11], v[80:81] op_sel:[0,1,0] op_sel_hi:[1,1,1]
    v_pk_fma_f32 v[92:93], v[66:67], v[10:11], v[82:83] op_sel:[0,1,0] op_sel_hi:[1,1,1]
    v_pk_fma_f32 v[96:97], v[68:69], v[10:11], v[84:85] op_sel:[0,1,0] op_sel_hi:[1,1,1]
    v_pk_fma_f32 v[100:101], v[70:71], v[10:11], v[86:87] op_sel:[0,1,0] op_sel_hi:[1,1,1]
    v_pk_fma_f32 v[88:89], v[160:161], v[10:11], v[88:89] op_sel_hi:[1,0,1]
    v_pk_fma_f32 v[92:93], v[162:163], v[10:11], v[92:93] op_sel_hi:[1,0,1]
    v_pk_fma_f32 v[96:97], v[164:165], v[10:11], v[96:97] op_sel_hi:[1,0,1]
    v_pk_fma_f32 v[100:101], v[166:167], v[10:11], v[100:101] op_sel_hi:[1,0,1]
    v_pk_mul_f32 v[90:91], v[88:89], v[88:89]
    v_pk_mul_f32 v[94:95], v[92:93], v[92:93]
    v_pk_mul_f32 v[98:99], v[96:97], v[96:97]
    v_pk_mul_f32 v[102:103], v[100:101], v[100:101]
    v_pk_fma_f32 v[90:91], v[90:91], v[14:15], v[12:13] op_sel_hi:[1,0,0]
    v_pk_fma_f32 v[94:95], v[94:95], v[14:15], v[12:13] op_sel_hi:[1,0,0]
    v_pk_fma_f32 v[98:99], v[98:99], v[14:15], v[12:13] op_sel_hi:[1,0,0]
    v_pk_fma_f32 v[102:103], v[102:103], v[14:15], v[12:13] op_sel_hi:[1,0,0]
    v_pk_mul_f32 v[90:91], v[90:91], v[88:89]
    v_pk_mul_f32 v[94:95], v[94:95], v[92:93]
    v_pk_mul_f32 v[98:99], v[98:99], v[96:97]
    v_pk_mul_f32 v[102:103], v[102:103], v[100:101]
    v_exp_f32 v90, v90
    v_exp_f32 v91, v91
    v_exp_f32 v94, v94
    v_exp_f32 v95, v95
    v_exp_f32 v98, v98
    v_exp_f32 v99, v99
    v_exp_f32 v102, v102
    v_exp_f32 v103, v103
    v_pk_add_f32 v[90:91], v[90:91], 1.0 op_sel_hi:[1,0]
    v_pk_add_f32 v[94:95], v[94:95], 1.0 op_sel_hi:[1,0]
    v_pk_add_f32 v[98:99], v[98:99], 1.0 op_sel_hi:[1,0]
    v_pk_add_f32 v[102:103], v[102:103], 1.0 op_sel_hi:[1,0]
    v_rcp_f32 v90, v90
    v_rcp_f32 v91, v91
    v_rcp_f32 v94, v94
    v_rcp_f32 v95, v95
    v_rcp_f32 v98, v98
    v_rcp_f32 v99, v99
    v_rcp_f32 v102, v102
    v_rcp_f32 v103, v103
    v_pk_mul_f32 v[88:89], v[88:89], v[90:91]
    v_pk_mul_f32 v[92:93], v[92:93], v[94:95]
    v_pk_mul_f32 v[96:97], v[96:97], v[98:99]
    v_pk_mul_f32 v[100:101], v[100:101], v[102:103]
    v_cvt_pk_bf16_f32 v156, v88, v89
    v_cvt_pk_bf16_f32 v157, v92, v93
    v_cvt_pk_bf16_f32 v158, v96, v97
    v_cvt_pk_bf16_f32 v159, v100, v101
    s_branch PB_HX
PB_H3:
    v_lshrrev_b32 v16, 5, v1
    v_lshlrev_b32 v16, 4, v16
    v_add_u32 v16, 140928, v16
    v_mov_b32 v12, 0xc0135761
    v_mov_b32 v14, 0xbdd2d3e8
    s_mul_i32 s62, s53, 114688
    s_lshl_b32 s54, s52, 11
    s_add_u32 s62, s62, s54
    s_add_u32 s62, s62, 16777216
    s_waitcnt lgkmcnt(0)
    s_nop 7
    ds_read_b128 v[24:27], v16 offset:0
    ds_read_b128 v[28:31], v16 offset:32
    ds_read_b128 v[32:35], v16 offset:64
    ds_read_b128 v[36:39], v16 offset:96
    ds_read_b128 v[40:43], v16 offset:512
    ds_read_b128 v[44:47], v16 offset:544
    ds_read_b128 v[48:51], v16 offset:576
    ds_read_b128 v[52:55], v16 offset:608
    s_waitcnt lgkmcnt(0)
    ds_read_b128 v[56:59], v16 offset:128
    ds_read_b128 v[60:63], v16 offset:160
    ds_read_b128 v[64:67], v16 offset:192
    ds_read_b128 v[68:71], v16 offset:224
    ds_read_b128 v[72:75], v16 offset:640
    ds_read_b128 v[76:79], v16 offset:672
    ds_read_b128 v[80:83], v16 offset:704
    ds_read_b128 v[84:87], v16 offset:736
    v_pk_fma_f32 v[88:89], v[24:25], v[10:11], v[40:41] op_sel:[0,1,0] op_sel_hi:[1,1,1]
    v_pk_fma_f32 v[92:93], v[26:27], v[10:11], v[42:43] op_sel:[0,1,0] op_sel_hi:[1,1,1]
    v_pk_fma_f32 v[96:97], v[28:29], v[10:11], v[44:45] op_sel:[0,1,0] op_sel_hi:[1,1,1]
    v_pk_fma_f32 v[100:101], v[30:31], v[10:11], v[46:47] op_sel:[0,1,0] op_sel_hi:[1,1,1]
    v_pk_fma_f32 v[88:89], v[104:105], v[10:11], v[88:89] op_sel_hi:[1,0,1]
    v_pk_fma_f32 v[92:93], v[106:107], v[10:11], v[92:93] op_sel_hi:[1,0,1]
    v_pk_fma_f32 v[96:97], v[108:109], v[10:11], v[96:97] op_sel_hi:[1,0,1]
    v_pk_fma_f32 v[100:101], v[110:111], v[10:11], v[100:101] op_sel_hi:[1,0,1]
    v_pk_mul_f32 v[90:91], v[88:89], v[88:89]
    v_pk_mul_f32 v[94:95], v[92:93], v[92:93]
    v_pk_mul_f32 v[98:99], v[96:97], v[96:97]
    v_pk_mul_f32 v[102:103], v[100:101], v[100:101]
    v_pk_fma_f32 v[90:91], v[90:91], v[14:15], v[12:13] op_sel_hi:[1,0,0]
    v_pk_fma_f32 v[94:95], v[94:95], v[14:15], v[12:13] op_sel_hi:[1,0,0]
    v_pk_fma_f32 v[98:99], v[98:99], v[14:15], v[12:13] op_sel_hi:[1,0,0]
    v_pk_fma_f32 v[102:103], v[102:103], v[14:15], v[12:13] op_sel_hi:[1,0,0]
    v_pk_mul_f32 v[90:91], v[90:91], v[88:89]
    v_pk_mul_f32 v[94:95], v[94:95], v[92:93]
    v_pk_mul_f32 v[98:99], v[98:99], v[96:97]
    v_pk_mul_f32 v[102:103], v[102:103], v[100:101]
    v_exp_f32 v90, v90
    v_exp_f32 v91, v91
    v_exp_f32 v94, v94
    v_exp_f32 v95, v95
    v_exp_f32 v98, v98
    v_exp_f32 v99, v99
    v_exp_f32 v102, v102
    v_exp_f32 v103, v103
    v_pk_add_f32 v[90:91], v[90:91], 1.0 op_sel_hi:[1,0]
    v_pk_add_f32 v[94:95], v[94:95], 1.0 op_sel_hi:[1,0]
    v_pk_add_f32 v[98:99], v[98:99], 1.0 op_sel_hi:[1,0]
    v_pk_add_f32 v[102:103], v[102:103], 1.0 op_sel_hi:[1,0]
    v_rcp_f32 v90, v90
    v_rcp_f32 v91, v91
    v_rcp_f32 v94, v94
    v_rcp_f32 v95, v95
    v_rcp_f32 v98, v98
    v_rcp_f32 v99, v99
    v_rcp_f32 v102, v102
    v_rcp_f32 v103, v103
    v_pk_mul_f32 v[88:89], v[88:89], v[90:91]
    v_pk_mul_f32 v[92:93], v[92:93], v[94:95]
    v_pk_mul_f32 v[96:97], v[96:97], v[98:99]
    v_pk_mul_f32 v[100:101], v[100:101], v[102:103]
    v_cvt_pk_bf16_f32 v104, v88, v89
    v_cvt_pk_bf16_f32 v105, v92, v93
    v_cvt_pk_bf16_f32 v106, v96, v97
    v_cvt_pk_bf16_f32 v107, v100, v101
    v_pk_fma_f32 v[88:89], v[32:33], v[10:11], v[48:49] op_sel:[0,1,0] op_sel_hi:[1,1,1]
    v_pk_fma_f32 v[92:93], v[34:35], v[10:11], v[50:51] op_sel:[0,1,0] op_sel_hi:[1,1,1]
    v_pk_fma_f32 v[96:97], v[36:37], v[10:11], v[52:53] op_sel:[0,1,0] op_sel_hi:[1,1,1]
    v_pk_fma_f32 v[100:101], v[38:39], v[10:11], v[54:55] op_sel:[0,1,0] op_sel_hi:[1,1,1]
    v_pk_fma_f32 v[88:89], v[112:113], v[10:11], v[88:89] op_sel_hi:[1,0,1]
    v_pk_fma_f32 v[92:93], v[114:115], v[10:11], v[92:93] op_sel_hi:[1,0,1]
    v_pk_fma_f32 v[96:97], v[116:117], v[10:11], v[96:97] op_sel_hi:[1,0,1]
    v_pk_fma_f32 v[100:101], v[118:119], v[10:11], v[100:101] op_sel_hi:[1,0,1]
    v_pk_mul_f32 v[90:91], v[88:89], v[88:89]
    v_pk_mul_f32 v[94:95], v[92:93], v[92:93]
    v_pk_mul_f32 v[98:99], v[96:97], v[96:97]
    v_pk_mul_f32 v[102:103], v[100:101], v[100:101]
    v_pk_fma_f32 v[90:91], v[90:91], v[14:15], v[12:13] op_sel_hi:[1,0,0]
    v_pk_fma_f32 v[94:95], v[94:95], v[14:15], v[12:13] op_sel_hi:[1,0,0]
    v_pk_fma_f32 v[98:99], v[98:99], v[14:15], v[12:13] op_sel_hi:[1,0,0]
    v_pk_fma_f32 v[102:103], v[102:103], v[14:15], v[12:13] op_sel_hi:[1,0,0]
    v_pk_mul_f32 v[90:91], v[90:91], v[88:89]
    v_pk_mul_f32 v[94:95], v[94:95], v[92:93]
    v_pk_mul_f32 v[98:99], v[98:99], v[96:97]
    v_pk_mul_f32 v[102:103], v[102:103], v[100:101]
    v_exp_f32 v90, v90
    v_exp_f32 v91, v91
    v_exp_f32 v94, v94
    v_exp_f32 v95, v95
    v_exp_f32 v98, v98
    v_exp_f32 v99, v99
    v_exp_f32 v102, v102
    v_exp_f32 v103, v103
    v_pk_add_f32 v[90:91], v[90:91], 1.0 op_sel_hi:[1,0]
    v_pk_add_f32 v[94:95], v[94:95], 1.0 op_sel_hi:[1,0]
    v_pk_add_f32 v[98:99], v[98:99], 1.0 op_sel_hi:[1,0]
    v_pk_add_f32 v[102:103], v[102:103], 1.0 op_sel_hi:[1,0]
    v_rcp_f32 v90, v90
    v_rcp_f32 v91, v91
    v_rcp_f32 v94, v94
    v_rcp_f32 v95, v95
    v_rcp_f32 v98, v98
    v_rcp_f32 v99, v99
    v_rcp_f32 v102, v102
    v_rcp_f32 v103, v103
    v_pk_mul_f32 v[88:89], v[88:89], v[90:91]
    v_pk_mul_f32 v[92:93], v[92:93], v[94:95]
    v_pk_mul_f32 v[96:97], v[96:97], v[98:99]
    v_pk_mul_f32 v[100:101], v[100:101], v[102:103]
    v_cvt_pk_bf16_f32 v108, v88, v89
    v_cvt_pk_bf16_f32 v109, v92, v93
    v_cvt_pk_bf16_f32 v110, v96, v97
    v_cvt_pk_bf16_f32 v111, v100, v101
    s_waitcnt lgkmcnt(0)
    ds_read_b128 v[24:27], v16 offset:256
    ds_read_b128 v[28:31], v16 offset:288
    ds_read_b128 v[32:35], v16 offset:320
    ds_read_b128 v[36:39], v16 offset:352
    ds_read_b128 v[40:43], v16 offset:768
    ds_read_b128 v[44:47], v16 offset:800
    ds_read_b128 v[48:51], v16 offset:832
    ds_read_b128 v[52:55], v16 offset:864
    v_pk_fma_f32 v[88:89], v[56:57], v[10:11], v[72:73] op_sel:[0,1,0] op_sel_hi:[1,1,1]
    v_pk_fma_f32 v[92:93], v[58:59], v[10:11], v[74:75] op_sel:[0,1,0] op_sel_hi:[1,1,1]
    v_pk_fma_f32 v[96:97], v[60:61], v[10:11], v[76:77] op_sel:[0,1,0] op_sel_hi:[1,1,1]
    v_pk_fma_f32 v[100:101], v[62:63], v[10:11], v[78:79] op_sel:[0,1,0] op_sel_hi:[1,1,1]
    v_pk_fma_f32 v[88:89], v[120:121], v[10:11], v[88:89] op_sel_hi:[1,0,1]
    v_pk_fma_f32 v[92:93], v[122:123], v[10:11], v[92:93] op_sel_hi:[1,0,1]
    v_pk_fma_f32 v[96:97], v[124:125], v[10:11], v[96:97] op_sel_hi:[1,0,1]
    v_pk_fma_f32 v[100:101], v[126:127], v[10:11], v[100:101] op_sel_hi:[1,0,1]
    v_pk_mul_f32 v[90:91], v[88:89], v[88:89]
    v_pk_mul_f32 v[94:95], v[92:93], v[92:93]
    v_pk_mul_f32 v[98:99], v[96:97], v[96:97]
    v_pk_mul_f32 v[102:103], v[100:101], v[100:101]
    v_pk_fma_f32 v[90:91], v[90:91], v[14:15], v[12:13] op_sel_hi:[1,0,0]
    v_pk_fma_f32 v[94:95], v[94:95], v[14:15], v[12:13] op_sel_hi:[1,0,0]
    v_pk_fma_f32 v[98:99], v[98:99], v[14:15], v[12:13] op_sel_hi:[1,0,0]
    v_pk_fma_f32 v[102:103], v[102:103], v[14:15], v[12:13] op_sel_hi:[1,0,0]
    v_pk_mul_f32 v[90:91], v[90:91], v[88:89]
    v_pk_mul_f32 v[94:95], v[94:95], v[92:93]
    v_pk_mul_f32 v[98:99], v[98:99], v[96:97]
    v_pk_mul_f32 v[102:103], v[102:103], v[100:101]
    v_exp_f32 v90, v90
    v_exp_f32 v91, v91
    v_exp_f32 v94, v94
    v_exp_f32 v95, v95
    v_exp_f32 v98, v98
    v_exp_f32 v99, v99
    v_exp_f32 v102, v102
    v_exp_f32 v103, v103
    v_pk_add_f32 v[90:91], v[90:91], 1.0 op_sel_hi:[1,0]
    v_pk_add_f32 v[94:95], v[94:95], 1.0 op_sel_hi:[1,0]
    v_pk_add_f32 v[98:99], v[98:99], 1.0 op_sel_hi:[1,0]
    v_pk_add_f32 v[102:103], v[102:103], 1.0 op_sel_hi:[1,0]
    v_rcp_f32 v90, v90
    v_rcp_f32 v91, v91
    v_rcp_f32 v94, v94
    v_rcp_f32 v95, v95
    v_rcp_f32 v98, v98
    v_rcp_f32 v99, v99
    v_rcp_f32 v102, v102
    v_rcp_f32 v103, v103
    v_pk_mul_f32 v[88:89], v[88:89], v[90:91]
    v_pk_mul_f32 v[92:93], v[92:93], v[94:95]
    v_pk_mul_f32 v[96:97], v[96:97], v[98:99]
    v_pk_mul_f32 v[100:101], v[100:101], v[102:103]
    v_cvt_pk_bf16_f32 v120, v88, v89
    v_cvt_pk_bf16_f32 v121, v92, v93
    v_cvt_pk_bf16_f32 v122, v96, v97
    v_cvt_pk_bf16_f32 v123, v100, v101
    v_pk_fma_f32 v[88:89], v[64:65], v[10:11], v[80:81] op_sel:[0,1,0] op_sel_hi:[1,1,1]
    v_pk_fma_f32 v[92:93], v[66:67], v[10:11], v[82:83] op_sel:[0,1,0] op_sel_hi:[1,1,1]
    v_pk_fma_f32 v[96:97], v[68:69], v[10:11], v[84:85] op_sel:[0,1,0] op_sel_hi:[1,1,1]
    v_pk_fma_f32 v[100:101], v[70:71], v[10:11], v[86:87] op_sel:[0,1,0] op_sel_hi:[1,1,1]
    v_pk_fma_f32 v[88:89], v[128:129], v[10:11], v[88:89] op_sel_hi:[1,0,1]
    v_pk_fma_f32 v[92:93], v[130:131], v[10:11], v[92:93] op_sel_hi:[1,0,1]
    v_pk_fma_f32 v[96:97], v[132:133], v[10:11], v[96:97] op_sel_hi:[1,0,1]
    v_pk_fma_f32 v[100:101], v[134:135], v[10:11], v[100:101] op_sel_hi:[1,0,1]
    v_pk_mul_f32 v[90:91], v[88:89], v[88:89]
    v_pk_mul_f32 v[94:95], v[92:93], v[92:93]
    v_pk_mul_f32 v[98:99], v[96:97], v[96:97]
    v_pk_mul_f32 v[102:103], v[100:101], v[100:101]
    v_pk_fma_f32 v[90:91], v[90:91], v[14:15], v[12:13] op_sel_hi:[1,0,0]
    v_pk_fma_f32 v[94:95], v[94:95], v[14:15], v[12:13] op_sel_hi:[1,0,0]
    v_pk_fma_f32 v[98:99], v[98:99], v[14:15], v[12:13] op_sel_hi:[1,0,0]
    v_pk_fma_f32 v[102:103], v[102:103], v[14:15], v[12:13] op_sel_hi:[1,0,0]
    v_pk_mul_f32 v[90:91], v[90:91], v[88:89]
    v_pk_mul_f32 v[94:95], v[94:95], v[92:93]
    v_pk_mul_f32 v[98:99], v[98:99], v[96:97]
    v_pk_mul_f32 v[102:103], v[102:103], v[100:101]
    v_exp_f32 v90, v90
    v_exp_f32 v91, v91
    v_exp_f32 v94, v94
    v_exp_f32 v95, v95
    v_exp_f32 v98, v98
    v_exp_f32 v99, v99
    v_exp_f32 v102, v102
    v_exp_f32 v103, v103
    v_pk_add_f32 v[90:91], v[90:91], 1.0 op_sel_hi:[1,0]
    v_pk_add_f32 v[94:95], v[94:95], 1.0 op_sel_hi:[1,0]
    v_pk_add_f32 v[98:99], v[98:99], 1.0 op_sel_hi:[1,0]
    v_pk_add_f32 v[102:103], v[102:103], 1.0 op_sel_hi:[1,0]
    v_rcp_f32 v90, v90
    v_rcp_f32 v91, v91
    v_rcp_f32 v94, v94
    v_rcp_f32 v95, v95
    v_rcp_f32 v98, v98
    v_rcp_f32 v99, v99
    v_rcp_f32 v102, v102
    v_rcp_f32 v103, v103
    v_pk_mul_f32 v[88:89], v[88:89], v[90:91]
    v_pk_mul_f32 v[92:93], v[92:93], v[94:95]
    v_pk_mul_f32 v[96:97], v[96:97], v[98:99]
    v_pk_mul_f32 v[100:101], v[100:101], v[102:103]
    v_cvt_pk_bf16_f32 v124, v88, v89
    v_cvt_pk_bf16_f32 v125, v92, v93
    v_cvt_pk_bf16_f32 v126, v96, v97
    v_cvt_pk_bf16_f32 v127, v100, v101
    s_waitcnt lgkmcnt(0)
    v_pk_fma_f32 v[88:89], v[24:25], v[10:11], v[40:41] op_sel:[0,1,0] op_sel_hi:[1,1,1]
    v_pk_fma_f32 v[92:93], v[26:27], v[10:11], v[42:43] op_sel:[0,1,0] op_sel_hi:[1,1,1]
    v_pk_fma_f32 v[96:97], v[28:29], v[10:11], v[44:45] op_sel:[0,1,0] op_sel_hi:[1,1,1]
    v_pk_fma_f32 v[100:101], v[30:31], v[10:11], v[46:47] op_sel:[0,1,0] op_sel_hi:[1,1,1]
    v_pk_fma_f32 v[88:89], v[136:137], v[10:11], v[88:89] op_sel_hi:[1,0,1]
    v_pk_fma_f32 v[92:93], v[138:139], v[10:11], v[92:93] op_sel_hi:[1,0,1]
    v_pk_fma_f32 v[96:97], v[140:141], v[10:11], v[96:97] op_sel_hi:[1,0,1]
    v_pk_fma_f32 v[100:101], v[142:143], v[10:11], v[100:101] op_sel_hi:[1,0,1]
    v_pk_mul_f32 v[90:91], v[88:89], v[88:89]
    v_pk_mul_f32 v[94:95], v[92:93], v[92:93]
    v_pk_mul_f32 v[98:99], v[96:97], v[96:97]
    v_pk_mul_f32 v[102:103], v[100:101], v[100:101]
    v_pk_fma_f32 v[90:91], v[90:91], v[14:15], v[12:13] op_sel_hi:[1,0,0]
    v_pk_fma_f32 v[94:95], v[94:95], v[14:15], v[12:13] op_sel_hi:[1,0,0]
    v_pk_fma_f32 v[98:99], v[98:99], v[14:15], v[12:13] op_sel_hi:[1,0,0]
    v_pk_fma_f32 v[102:103], v[102:103], v[14:15], v[12:13] op_sel_hi:[1,0,0]
    v_pk_mul_f32 v[90:91], v[90:91], v[88:89]
    v_pk_mul_f32 v[94:95], v[94:95], v[92:93]
    v_pk_mul_f32 v[98:99], v[98:99], v[96:97]
    v_pk_mul_f32 v[102:103], v[102:103], v[100:101]
    v_exp_f32 v90, v90
    v_exp_f32 v91, v91
    v_exp_f32 v94, v94
    v_exp_f32 v95, v95
    v_exp_f32 v98, v98
    v_exp_f32 v99, v99
    v_exp_f32 v102, v102
    v_exp_f32 v103, v103
    v_pk_add_f32 v[90:91], v[90:91], 1.0 op_sel_hi:[1,0]
    v_pk_add_f32 v[94:95], v[94:95], 1.0 op_sel_hi:[1,0]
    v_pk_add_f32 v[98:99], v[98:99], 1.0 op_sel_hi:[1,0]
    v_pk_add_f32 v[102:103], v[102:103], 1.0 op_sel_hi:[1,0]
    v_rcp_f32 v90, v90
    v_rcp_f32 v91, v91
    v_rcp_f32 v94, v94
    v_rcp_f32 v95, v95
    v_rcp_f32 v98, v98
    v_rcp_f32 v99, v99
    v_rcp_f32 v102, v102
    v_rcp_f32 v103, v103
    v_pk_mul_f32 v[88:89], v[88:89], v[90:91]
    v_pk_mul_f32 v[92:93], v[92:93], v[94:95]
    v_pk_mul_f32 v[96:97], v[96:97], v[98:99]
    v_pk_mul_f32 v[100:101], v[100:101], v[102:103]
    v_cvt_pk_bf16_f32 v136, v88, v89
    v_cvt_pk_bf16_f32 v137, v92, v93
    v_cvt_pk_bf16_f32 v138, v96, v97
    v_cvt_pk_bf16_f32 v139, v100, v101
    v_pk_fma_f32 v[88:89], v[32:33], v[10:11], v[48:49] op_sel:[0,1,0] op_sel_hi:[1,1,1]
    v_pk_fma_f32 v[92:93], v[34:35], v[10:11], v[50:51] op_sel:[0,1,0] op_sel_hi:[1,1,1]
    v_pk_fma_f32 v[96:97], v[36:37], v[10:11], v[52:53] op_sel:[0,1,0] op_sel_hi:[1,1,1]
    v_pk_fma_f32 v[100:101], v[38:39], v[10:11], v[54:55] op_sel:[0,1,0] op_sel_hi:[1,1,1]
    v_pk_fma_f32 v[88:89], v[144:145], v[10:11], v[88:89] op_sel_hi:[1,0,1]
    v_pk_fma_f32 v[92:93], v[146:147], v[10:11], v[92:93] op_sel_hi:[1,0,1]
    v_pk_fma_f32 v[96:97], v[148:149], v[10:11], v[96:97] op_sel_hi:[1,0,1]
    v_pk_fma_f32 v[100:101], v[150:151], v[10:11], v[100:101] op_sel_hi:[1,0,1]
    v_pk_mul_f32 v[90:91], v[88:89], v[88:89]
    v_pk_mul_f32 v[94:95], v[92:93], v[92:93]
    v_pk_mul_f32 v[98:99], v[96:97], v[96:97]
    v_pk_mul_f32 v[102:103], v[100:101], v[100:101]
    v_pk_fma_f32 v[90:91], v[90:91], v[14:15], v[12:13] op_sel_hi:[1,0,0]
    v_pk_fma_f32 v[94:95], v[94:95], v[14:15], v[12:13] op_sel_hi:[1,0,0]
    v_pk_fma_f32 v[98:99], v[98:99], v[14:15], v[12:13] op_sel_hi:[1,0,0]
    v_pk_fma_f32 v[102:103], v[102:103], v[14:15], v[12:13] op_sel_hi:[1,0,0]
    v_pk_mul_f32 v[90:91], v[90:91], v[88:89]
    v_pk_mul_f32 v[94:95], v[94:95], v[92:93]
    v_pk_mul_f32 v[98:99], v[98:99], v[96:97]
    v_pk_mul_f32 v[102:103], v[102:103], v[100:101]
    v_exp_f32 v90, v90
    v_exp_f32 v91, v91
    v_exp_f32 v94, v94
    v_exp_f32 v95, v95
    v_exp_f32 v98, v98
    v_exp_f32 v99, v99
    v_exp_f32 v102, v102
    v_exp_f32 v103, v103
    v_pk_add_f32 v[90:91], v[90:91], 1.0 op_sel_hi:[1,0]
    v_pk_add_f32 v[94:95], v[94:95], 1.0 op_sel_hi:[1,0]
    v_pk_add_f32 v[98:99], v[98:99], 1.0 op_sel_hi:[1,0]
    v_pk_add_f32 v[102:103], v[102:103], 1.0 op_sel_hi:[1,0]
    v_rcp_f32 v90, v90
    v_rcp_f32 v91, v91
    v_rcp_f32 v94, v94
    v_rcp_f32 v95, v95
    v_rcp_f32 v98, v98
    v_rcp_f32 v99, v99
    v_rcp_f32 v102, v102
    v_rcp_f32 v103, v103
    v_pk_mul_f32 v[88:89], v[88:89], v[90:91]
    v_pk_mul_f32 v[92:93], v[92:93], v[94:95]
    v_pk_mul_f32 v[96:97], v[96:97], v[98:99]
    v_pk_mul_f32 v[100:101], v[100:101], v[102:103]
    v_cvt_pk_bf16_f32 v140, v88, v89
    v_cvt_pk_bf16_f32 v141, v92, v93
    v_cvt_pk_bf16_f32 v142, v96, v97
    v_cvt_pk_bf16_f32 v143, v100, v101
PB_HX:
    s_mov_b32 s94, s59
    s_and_b32 s54, s2, 7
    s_lshr_b32 s55, s2, 3
    s_lshl_b32 s54, s54, 2
    s_lshr_b32 s56, s55, 3
    s_add_u32 s58, s54, s56
    s_and_b32 s59, s55, 7
    s_waitcnt lgkmcnt(0)
    s_barrier
    buffer_store_dwordx4 v[104:107], v2, s[28:31], s62 offen offset:0 sc1
    buffer_store_dwordx4 v[108:111], v2, s[28:31], s62 offen offset:1024 sc1
    s_add_u32 s62, s62, 2048
    buffer_store_dwordx4 v[120:123], v2, s[28:31], s62 offen offset:0 sc1
    buffer_store_dwordx4 v[124:127], v2, s[28:31], s62 offen offset:1024 sc1
    s_add_u32 s62, s62, 2048
    buffer_store_dwordx4 v[136:139], v2, s[28:31], s62 offen offset:0 sc1
    buffer_store_dwordx4 v[140:143], v2, s[28:31], s62 offen offset:1024 sc1
    s_add_u32 s62, s62, 2048
    s_bitcmp1_b32 s51, 0
    s_cbranch_scc1 PB_HS3
    buffer_store_dwordx4 v[152:155], v2, s[28:31], s62 offen offset:0 sc1
    buffer_store_dwordx4 v[156:159], v2, s[28:31], s62 offen offset:1024 sc1
PB_HS3:
    s_nop 1
    s_and_b32 s60, s48, 3
    s_lshr_b32 s61, s48, 2
    s_lshl_b32 s54, s61, 15
    v_add_u32 v148, s54, v2
    v_and_b32 v3, 31, v1
    v_lshrrev_b32 v153, 5, v1
    v_lshlrev_b32 v153, 8, v153
    v_lshlrev_b32 v154, 4, v3
    v_add_u32 v153, v153, v154
    s_add_u32 s55, s54, 65536
    v_add_u32 v153, s55, v153
    v_subrev_u32 v154, 20, v3
    v_cmp_gt_u32 vcc, 8, v154
    v_mov_b32 v155, 131072
    v_mov_b32 v156, 131136
    v_cndmask_b32 v155, v155, v156, vcc
    v_cmp_gt_u32 vcc, 16, v3
    v_mov_b32 v156, 8192
    s_nop 0
    v_cndmask_b32 v149, v155, v153, vcc
    v_cndmask_b32 v150, 0, v156, vcc
    v_mov_b32 v116, 0
    v_mov_b32 v117, 0
    v_mov_b32 v118, 0
    v_mov_b32 v119, 0
    v_mov_b32 v120, 0
    v_mov_b32 v121, 0
    v_mov_b32 v122, 0
    v_mov_b32 v123, 0
    v_mov_b32 v124, 0
    v_mov_b32 v125, 0
    v_mov_b32 v126, 0
    v_mov_b32 v127, 0
    v_mov_b32 v128, 0
    v_mov_b32 v129, 0
    v_mov_b32 v130, 0
    v_mov_b32 v131, 0
    v_mov_b32 v132, 0
    v_mov_b32 v133, 0
    v_mov_b32 v134, 0
    v_mov_b32 v135, 0
    v_mov_b32 v136, 0
    v_mov_b32 v137, 0
    v_mov_b32 v138, 0
    v_mov_b32 v139, 0
    v_mov_b32 v140, 0
    v_mov_b32 v141, 0
    v_mov_b32 v142, 0
    v_mov_b32 v143, 0
    v_mov_b32 v144, 0
    v_mov_b32 v145, 0
    v_mov_b32 v146, 0
    v_mov_b32 v147, 0
    s_mov_b32 s27, 0
    s_lshl_b32 s54, s60, 11
    s_add_u32 s54, s54, 153728
    v_add_u32 v153, s54, v2
    ds_read_b128 v[4:7], v153
    ds_read_b128 v[8:11], v153 offset:1024
    s_branch FZ_MAIN
PB_HELP:
    s_waitcnt lgkmcnt(0)
    s_mov_b32 s44, s22
    s_mov_b32 s45, s23
    s_mov_b32 s46, 256
    s_mov_b32 s47, 0x20000
    v_mov_b32 v47, 0
    s_cmp_eq_u32 s49, 0
    s_cbranch_scc0 PB_H_ntag
    v_lshlrev_b32 v20, 2, v1
    v_add_u32 v20, 140292, v20
    s_mov_b64 exec, 127
    ds_write_b32 v20, v47
    s_mov_b64 exec, -1
    s_cmp_eq_u32 s2, 0
    s_cbranch_scc0 PB_H_ntag
    s_memrealtime s[54:55]
    s_waitcnt lgkmcnt(0)
    s_or_b32 s54, s54, 1
    v_mov_b32 v46, s54
    s_mov_b64 exec, 1
    buffer_store_dword v46, v47, s[44:47], 0 offen offset:252 sc1
    s_mov_b64 exec, -1
PB_H_ntag:
    s_lshr_b32 s54, s2, 3
    s_lshr_b32 s55, s2, 1
    s_and_b32 s55, s55, 3
    s_and_b32 s56, s2, 1
    s_mov_b32 s65, 0
    s_cmp_eq_u32 s49, 0
    s_cbranch_scc1 PB_PF_g0
    s_cmp_eq_u32 s49, 1
    s_cbranch_scc1 PB_PF_g1
    s_cmp_eq_u32 s49, 2
    s_cbranch_scc1 PB_PF_g2
    s_mov_b32 s32, s4
    s_mov_b32 s33, s5
    s_mov_b32 s34, 2097152
    s_mov_b32 s35, 0x20000
    s_mov_b32 s65, 8
    s_mov_b32 s62, 0
    s_mov_b32 s63, 0
    s_mov_b64 s[94:95], 1
    v_mov_b32 v44, 0
    s_branch PB_PF_go
PB_PF_g0:
    s_mov_b32 s32, s4
    s_mov_b32 s33, s5
    s_mov_b32 s34, 2097152
    s_mov_b32 s35, 0x20000
    v_lshlrev_b32 v44, 10, v1
    v_cmp_gt_u32 vcc, 32, v1
    s_lshl_b32 s56, s56, 20
    s_lshl_b32 s54, s54, 15
    s_add_u32 s62, s54, s56
    s_add_u32 s62, s62, 0
    s_mov_b32 s63, 128
    s_mov_b64 s[94:95], vcc
    s_branch PB_PF_go
PB_PF_g1:
    s_mov_b32 s32, s6
    s_mov_b32 s33, s7
    s_mov_b32 s34, 1572864
    s_mov_b32 s35, 0x20000
    v_cmp_le_u32 vcc, 6, v1
    v_mov_b32 v20, 0
    v_mov_b32 v21, 6
    v_cndmask_b32 v21, v20, v21, vcc
    v_sub_u32 v22, v1, v21
    v_mov_b32 v21, 3072
    v_cndmask_b32 v21, v20, v21, vcc
    v_lshrrev_b32 v23, 1, v22
    v_and_b32 v22, 1, v22
    v_lshlrev_b32 v23, 10, v23
    v_lshlrev_b32 v22, 7, v22
    v_add_u32 v22, v22, v23
    v_add_u32 v44, v21, v22
    v_cmp_gt_u32 vcc, 12, v1
    s_mul_i32 s55, s55, 256
    s_mul_i32 s54, s54, 6144
    s_add_u32 s62, s54, s55
    s_add_u32 s62, s62, 0
    s_mov_b32 s63, 196608
    s_mov_b64 s[94:95], vcc
    s_branch PB_PF_go
PB_PF_g2:
    s_mov_b32 s32, s12
    s_mov_b32 s33, s13
    s_mov_b32 s34, 1835008
    s_mov_b32 s35, 0x20000
    v_cmp_le_u32 vcc, 7, v1
    v_mov_b32 v20, 0
    v_mov_b32 v21, 7
    v_cndmask_b32 v21, v20, v21, vcc
    v_sub_u32 v22, v1, v21
    v_mov_b32 v21, 3584
    v_cndmask_b32 v21, v20, v21, vcc
    v_lshlrev_b32 v22, 7, v22
    v_add_u32 v44, v21, v22
    v_cmp_gt_u32 vcc, 14, v1
    s_mul_i32 s55, s55, 896
    s_mul_i32 s54, s54, 7168
    s_add_u32 s62, s54, s55
    s_add_u32 s62, s62, 0
    s_mov_b32 s63, 229376
    s_mov_b64 s[94:95], vcc
PB_PF_go:
    s_cmp_lt_u32 s65, 8
    s_cbranch_scc0 PB_PF_x2_2413
    s_mov_b64 exec, s[94:95]
    buffer_load_dword v45, v44, s[32:35], s62 offen
    s_mov_b64 exec, -1
    s_add_u32 s62, s62, s63
    s_add_u32 s65, s65, 1
    s_cmp_lt_u32 s65, 8
    s_cbranch_scc0 PB_PF_x2_2413
    s_mov_b64 exec, s[94:95]
    buffer_load_dword v45, v44, s[32:35], s62 offen
    s_mov_b64 exec, -1
    s_add_u32 s62, s62, s63
    s_add_u32 s65, s65, 1
PB_PF_x2_2413:
PB_HLOOP:
    s_barrier
    ds_read_b128 v[24:27], v3
    ds_read_b128 v[28:31], v4
    ds_read_b128 v[32:35], v5
    ds_read_b128 v[36:39], v6
    s_cmp_lt_u32 s65, 8
    s_cbranch_scc0 PB_PF_x2_2434
    s_mov_b64 exec, s[94:95]
    buffer_load_dword v45, v44, s[32:35], s62 offen
    s_mov_b64 exec, -1
    s_add_u32 s62, s62, s63
    s_add_u32 s65, s65, 1
    s_cmp_lt_u32 s65, 8
    s_cbranch_scc0 PB_PF_x2_2434
    s_mov_b64 exec, s[94:95]
    buffer_load_dword v45, v44, s[32:35], s62 offen
    s_mov_b64 exec, -1
    s_add_u32 s62, s62, s63
    s_add_u32 s65, s65, 1
PB_PF_x2_2434:
    s_cmp_eq_u32 s26, 5
    s_cbranch_scc0 PB_H_nt5
    buffer_load_dword v46, v47, s[44:47], 0 offen offset:252 sc1
PB_H_nt5:
    s_cmp_eq_u32 s71, 2
    s_mov_b32 s54, 45056
    s_cmov_b32 s54, -90112
    s_waitcnt lgkmcnt(3)
    v_lshlrev_b32 v40, 16, v24
    v_and_b32 v41, s92, v24
    v_add_f32 v12, v12, v40
    v_add_f32 v13, v13, v41
    v_fma_f32 v14, v40, v40, v14
    v_fma_f32 v15, v41, v41, v15
    v_lshlrev_b32 v42, 16, v25
    v_and_b32 v43, s92, v25
    v_add_f32 v12, v12, v42
    v_add_f32 v13, v13, v43
    v_fma_f32 v14, v42, v42, v14
    v_fma_f32 v15, v43, v43, v15
    v_lshlrev_b32 v40, 16, v26
    v_and_b32 v41, s92, v26
    v_add_f32 v12, v12, v40
    v_add_f32 v13, v13, v41
    v_fma_f32 v14, v40, v40, v14
    v_fma_f32 v15, v41, v41, v15
    v_lshlrev_b32 v42, 16, v27
    v_and_b32 v43, s92, v27
    v_add_f32 v12, v12, v42
    v_add_f32 v13, v13, v43
    v_fma_f32 v14, v42, v42, v14
    v_fma_f32 v15, v43, v43, v15
    s_waitcnt lgkmcnt(2)
    v_lshlrev_b32 v40, 16, v28
    v_and_b32 v41, s92, v28
    v_add_f32 v12, v12, v40
    v_add_f32 v13, v13, v41
    v_fma_f32 v14, v40, v40, v14
    v_fma_f32 v15, v41, v41, v15
    v_lshlrev_b32 v42, 16, v29
    v_and_b32 v43, s92, v29
    v_add_f32 v12, v12, v42
    v_add_f32 v13, v13, v43
    v_fma_f32 v14, v42, v42, v14
    v_fma_f32 v15, v43, v43, v15
    v_lshlrev_b32 v40, 16, v30
    v_and_b32 v41, s92, v30
    v_add_f32 v12, v12, v40
    v_add_f32 v13, v13, v41
    v_fma_f32 v14, v40, v40, v14
    v_fma_f32 v15, v41, v41, v15
    v_lshlrev_b32 v42, 16, v31
    v_and_b32 v43, s92, v31
    v_add_f32 v12, v12, v42
    v_add_f32 v13, v13, v43
    v_fma_f32 v14, v42, v42, v14
    v_fma_f32 v15, v43, v43, v15
    s_waitcnt lgkmcnt(1)
    v_lshlrev_b32 v40, 16, v32
    v_and_b32 v41, s92, v32
    v_add_f32 v12, v12, v40
    v_add_f32 v13, v13, v41
    v_fma_f32 v14, v40, v40, v14
    v_fma_f32 v15, v41, v41, v15
    v_lshlrev_b32 v42, 16, v33
    v_and_b32 v43, s92, v33
    v_add_f32 v12, v12, v42
    v_add_f32 v13, v13, v43
    v_fma_f32 v14, v42, v42, v14
    v_fma_f32 v15, v43, v43, v15
    v_lshlrev_b32 v40, 16, v34
    v_and_b32 v41, s92, v34
    v_add_f32 v12, v12, v40
    v_add_f32 v13, v13, v41
    v_fma_f32 v14, v40, v40, v14
    v_fma_f32 v15, v41, v41, v15
    v_lshlrev_b32 v42, 16, v35
    v_and_b32 v43, s92, v35
    v_add_f32 v12, v12, v42
    v_add_f32 v13, v13, v43
    v_fma_f32 v14, v42, v42, v14
    v_fma_f32 v15, v43, v43, v15
    s_waitcnt lgkmcnt(0)
    v_lshlrev_b32 v40, 16, v36
    v_and_b32 v41, s92, v36
    v_add_f32 v12, v12, v40
    v_add_f32 v13, v13, v41
    v_fma_f32 v14, v40, v40, v14
    v_fma_f32 v15, v41, v41, v15
    v_lshlrev_b32 v42, 16, v37
    v_and_b32 v43, s92, v37
    v_add_f32 v12, v12, v42
    v_add_f32 v13, v13, v43
    v_fma_f32 v14, v42, v42, v14
    v_fma_f32 v15, v43, v43, v15
    v_lshlrev_b32 v40, 16, v38
    v_and_b32 v41, s92, v38
    v_add_f32 v12, v12, v40
    v_add_f32 v13, v13, v41
    v_fma_f32 v14, v40, v40, v14
    v_fma_f32 v15, v41, v41, v15
    v_lshlrev_b32 v42, 16, v39
    v_and_b32 v43, s92, v39
    v_add_f32 v12, v12, v42
    v_add_f32 v13, v13, v43
    v_fma_f32 v14, v42, v42, v14
    v_fma_f32 v15, v43, v43, v15
    v_add_u32 v3, s54, v3
    v_add_u32 v4, s54, v4
    v_add_u32 v5, s54, v5
    v_add_u32 v6, s54, v6
    s_add_u32 s71, s71, 1
    s_cmp_eq_u32 s71, 3
    s_cselect_b32 s71, 0, s71
    s_add_u32 s26, s26, 1
    s_cmp_lt_u32 s26, 8
    s_cbranch_scc1 PB_HLOOP
    s_barrier
    v_and_b32 v8, 31, v1
    s_lshl_b32 s54, s49, 7
    v_lshlrev_b32 v24, 2, v8
    v_add_f32 v20, v12, v13
    v_add_f32 v21, v14, v15
    v_mov_b32 v22, v20
    v_mov_b32 v23, v21
    s_nop 1
    v_permlane32_swap_b32 v20, v22
    v_permlane32_swap_b32 v21, v23
    s_nop 1
    v_add_f32 v20, v20, v22
    v_add_f32 v21, v21, v23
    v_mul_f32 v22, 0x3b000000, v20
    v_mul_f32 v23, 0x3b000000, v21
    v_fma_f32 v23, -v22, v22, v23
    v_max_f32 v23, 0, v23
    v_add_f32 v20, 0x3727c5ac, v23
    v_rsq_f32 v20, v20
    s_nop 0
    v_mul_f32 v21, v20, v20
    v_mul_f32 v21, v21, v23
    v_add_f32 v21, 0x3727c5ac, v21
    v_rsq_f32 v21, v21
    v_add_u32 v25, s54, v24
    v_lshlrev_b32 v26, 1, v25
    v_add_u32 v25, 141952, v25
    v_add_u32 v26, 142976, v26
    v_mul_f32 v29, v22, v20
    v_mul_f32 v30, v20, v21
    v_sub_f32 v29, 0, v29
    ds_write_b32 v25, v20
    v_mul_f32 v31, v29, v21
    ds_write_b32 v25, v29 offset:512
    ds_write_b64 v26, v[30:31]
    s_mov_b32 s65, 0
PB_H_tagp:
    s_waitcnt vmcnt(0)
    v_readfirstlane_b32 s71, v46
    s_add_u32 s65, s65, 1
    s_cmp_ge_u32 s65, 65536
    s_cbranch_scc1 PB_H_tagx
    s_cmp_eq_u32 s71, 0
    s_cbranch_scc0 PB_H_tagx
    s_sleep 4
    buffer_load_dword v46, v47, s[44:47], 0 offen offset:252 sc1
    s_branch PB_H_tagp
PB_H_tagx:
    v_mov_b32 v27, 140288
    v_mov_b32 v28, s71
    s_mov_b64 exec, 1
    ds_write_b32 v27, v28
    s_mov_b64 exec, -1
    s_waitcnt lgkmcnt(0)
    s_barrier
    s_waitcnt vmcnt(0)
    s_and_b32 s54, s2, 7
    s_lshr_b32 s55, s2, 3
    s_lshl_b32 s54, s54, 2
    s_lshr_b32 s56, s55, 3
    s_add_u32 s58, s54, s56
    s_and_b32 s59, s55, 7
    s_mov_b32 s28, s24
    s_mov_b32 s29, s25
    s_mov_b32 s30, 25165824
    s_mov_b32 s31, 0x20000
    s_lshl_b32 s55, s49, 11
    s_add_u32 s55, s55, 131072
    v_add_u32 v3, s55, v2
    v_mov_b32 v24, 0x3f803f80
    v_mov_b32 v25, 0x3f803f80
    v_mov_b32 v26, 0x3f803f80
    v_mov_b32 v27, 0x3f803f80
    ds_write_b128 v3, v[24:27]
    ds_write_b128 v3, v[24:27] offset:1024
    v_add_u32 v3, 139264, v2
    ds_write_b128 v3, v[24:27]
    s_lshr_b32 s54, s58, 1
    s_lshl_b32 s54, s54, 8
    s_add_u32 s54, s54, 14745600
    v_and_b32 v4, 15, v1
    v_lshlrev_b32 v4, 4, v4
    v_add_u32 v4, s54, v4
    s_lshl_b32 s54, s58, 16
    s_lshl_b32 s64, s49, 11
    s_lshl_b32 s55, s59, 13
    s_add_u32 s57, s54, s64
    s_add_u32 s57, s57, s55
    s_add_u32 s63, s54, 4194304
    s_add_u32 s62, s54, 2097152
    s_mul_i32 s95, s59, 0
    s_add_u32 s95, s95, s64
    s_cmp_eq_u32 s49, 0
    s_cbranch_scc0 FZ_QW
    v_mov_b32 v6, 140300
    s_mov_b32 s100, 0
FZ_QO:
    ds_read_b32 v5, v6
    s_add_u32 s100, s100, 1
    s_waitcnt lgkmcnt(0)
    v_readfirstlane_b32 s54, v5
    s_cmp_ge_u32 s100, 1048576
    s_cbranch_scc1 FZ_QOx
    s_cmp_ge_u32 s54, 4
    s_cbranch_scc1 FZ_QOx
    s_sleep 1
    s_branch FZ_QO
FZ_QOx:
    s_mov_b32 s100, 0
FZ_QP:
    buffer_load_dword v5, v4, s[28:31], 0 offen sc1
    s_add_u32 s100, s100, 1
    s_waitcnt vmcnt(0)
    v_cmp_ne_u32 vcc, s71, v5
    s_cmp_ge_u32 s100, 65536
    s_cbranch_scc1 FZ_QPX
    s_cbranch_vccz FZ_QPX
    s_sleep 4
    s_branch FZ_QP
FZ_QPX:
    v_mov_b32 v5, 1
    v_mov_b32 v6, 140312
    ds_write_b32 v6, v5
    s_branch FZ_QGO
FZ_QW:
    v_mov_b32 v6, 140312
    s_mov_b32 s100, 0
FZ_QS:
    ds_read_b32 v5, v6
    s_add_u32 s100, s100, 1
    s_waitcnt lgkmcnt(0)
    v_readfirstlane_b32 s54, v5
    s_cmp_ge_u32 s100, 1048576
    s_cbranch_scc1 FZ_QSx
    s_cmp_ge_u32 s54, 1
    s_cbranch_scc1 FZ_QSx
    s_sleep 1
    s_branch FZ_QS
FZ_QSx:
FZ_QGO:
    s_add_u32 s54, s57, 0
    s_add_u32 m0, s64, 153728
    s_nop 0
    buffer_load_dwordx4 v2, s[28:31], s54 offen sc1 lds
    s_add_u32 s54, s57, 1024
    s_add_u32 m0, s64, 154752
    s_nop 0
    buffer_load_dwordx4 v2, s[28:31], s54 offen sc1 lds
    s_add_u32 s55, s95, 0
    s_and_b32 s55, s55, 0x7fff
    s_add_u32 s54, s55, s62
    s_add_u32 m0, s64, 0
    s_nop 0
    buffer_load_dwordx4 v2, s[28:31], s54 offen sc1 lds
    s_add_u32 s54, s55, s63
    s_add_u32 m0, s64, 65536
    s_nop 0
    buffer_load_dwordx4 v2, s[28:31], s54 offen sc1 lds
    s_add_u32 s55, s95, 1024
    s_and_b32 s55, s55, 0x7fff
    s_add_u32 s54, s55, s62
    s_add_u32 m0, s64, 1024
    s_nop 0
    buffer_load_dwordx4 v2, s[28:31], s54 offen sc1 lds
    s_add_u32 s54, s55, s63
    s_add_u32 m0, s64, 66560
    s_nop 0
    buffer_load_dwordx4 v2, s[28:31], s54 offen sc1 lds
    s_add_u32 s55, s95, 0
    s_and_b32 s55, s55, 0x7fff
    s_add_u32 s55, s55, 32768
    s_add_u32 s54, s55, s62
    s_add_u32 m0, s64, 32768
    s_nop 0
    buffer_load_dwordx4 v2, s[28:31], s54 offen sc1 lds
    s_add_u32 s54, s55, s63
    s_add_u32 m0, s64, 98304
    s_nop 0
    buffer_load_dwordx4 v2, s[28:31], s54 offen sc1 lds
    s_add_u32 s55, s95, 1024
    s_and_b32 s55, s55, 0x7fff
    s_add_u32 s55, s55, 32768
    s_add_u32 s54, s55, s62
    s_add_u32 m0, s64, 33792
    s_nop 0
    buffer_load_dwordx4 v2, s[28:31], s54 offen sc1 lds
    s_add_u32 s54, s55, s63
    s_add_u32 m0, s64, 99328
    s_nop 0
    buffer_load_dwordx4 v2, s[28:31], s54 offen sc1 lds
    v_mov_b32 v5, 1
    v_mov_b32 v6, 140316
    s_mov_b64 exec, 1
    ds_add_u32 v6, v5
    s_mov_b64 exec, -1
FZ_ATT:
    s_and_b32 s60, s48, 3
    s_lshr_b32 s61, s48, 2
    s_lshl_b32 s54, s61, 15
    v_add_u32 v148, s54, v2
    v_and_b32 v3, 31, v1
    v_lshrrev_b32 v153, 5, v1
    v_lshlrev_b32 v153, 8, v153
    v_lshlrev_b32 v154, 4, v3
    v_add_u32 v153, v153, v154
    s_add_u32 s55, s54, 65536
    v_add_u32 v153, s55, v153
    v_subrev_u32 v154, 20, v3
    v_cmp_gt_u32 vcc, 8, v154
    v_mov_b32 v155, 131072
    v_mov_b32 v156, 131136
    v_cndmask_b32 v155, v155, v156, vcc
    v_cmp_gt_u32 vcc, 16, v3
    v_mov_b32 v156, 8192
    s_nop 0
    v_cndmask_b32 v149, v155, v153, vcc
    v_cndmask_b32 v150, 0, v156, vcc
    v_mov_b32 v116, 0
    v_mov_b32 v117, 0
    v_mov_b32 v118, 0
    v_mov_b32 v119, 0
    v_mov_b32 v120, 0
    v_mov_b32 v121, 0
    v_mov_b32 v122, 0
    v_mov_b32 v123, 0
    v_mov_b32 v124, 0
    v_mov_b32 v125, 0
    v_mov_b32 v126, 0
    v_mov_b32 v127, 0
    v_mov_b32 v128, 0
    v_mov_b32 v129, 0
    v_mov_b32 v130, 0
    v_mov_b32 v131, 0
    v_mov_b32 v132, 0
    v_mov_b32 v133, 0
    v_mov_b32 v134, 0
    v_mov_b32 v135, 0
    v_mov_b32 v136, 0
    v_mov_b32 v137, 0
    v_mov_b32 v138, 0
    v_mov_b32 v139, 0
    v_mov_b32 v140, 0
    v_mov_b32 v141, 0
    v_mov_b32 v142, 0
    v_mov_b32 v143, 0
    v_mov_b32 v144, 0
    v_mov_b32 v145, 0
    v_mov_b32 v146, 0
    v_mov_b32 v147, 0
    s_mov_b32 s27, 0
    s_lshl_b32 s54, s60, 11
    s_add_u32 s54, s54, 153728
    v_add_u32 v153, s54, v2
    s_waitcnt vmcnt(0) lgkmcnt(0)
    s_barrier
    ds_read_b128 v[4:7], v153
    ds_read_b128 v[8:11], v153 offset:1024
FZ_MAIN:
    ds_read_b128 v[12:15], v148
    ds_read_b128 v[20:23], v149
    ds_read_b128 v[24:27], v149 offset:512
    s_waitcnt lgkmcnt(2)
    v_mfma_f32_32x32x16_bf16 v[68:83], v[12:15], v[4:7], 0
    v_mfma_f32_32x32x16_bf16 v[84:99], v[12:15], v[8:11], 0
    s_nop 7
    s_nop 3
    v_max3_f32 v151, v68, v69, v70
    v_max3_f32 v151, v151, v71, v72
    v_max3_f32 v151, v151, v73, v74
    v_max3_f32 v151, v151, v75, v76
    v_max3_f32 v151, v151, v77, v78
    v_max3_f32 v151, v151, v79, v80
    v_max3_f32 v151, v151, v81, v82
    v_max_f32 v151, v151, v83
    s_nop 7
    v_max3_f32 v152, v84, v85, v86
    v_max3_f32 v152, v152, v87, v88
    v_max3_f32 v152, v152, v89, v90
    v_max3_f32 v152, v152, v91, v92
    v_max3_f32 v152, v152, v93, v94
    v_max3_f32 v152, v152, v95, v96
    v_max3_f32 v152, v152, v97, v98
    v_max_f32 v152, v152, v99
K2_SETM:
    v_mov_b32 v153, v151
    v_mov_b32 v154, v152
    s_nop 1
    v_permlane32_swap_b32 v151, v153
    v_permlane32_swap_b32 v152, v154
    s_nop 1
    v_max_f32 v151, v151, v153
    v_max_f32 v152, v152, v154
    v_mul_f32 v36, -1.0, v151
    v_mul_f32 v37, -1.0, v151
    v_mul_f32 v38, -1.0, v151
    v_mul_f32 v39, -1.0, v151
    v_mul_f32 v40, -1.0, v151
    v_mul_f32 v41, -1.0, v151
    v_mul_f32 v42, -1.0, v151
    v_mul_f32 v43, -1.0, v151
    v_mul_f32 v44, -1.0, v151
    v_mul_f32 v45, -1.0, v151
    v_mul_f32 v46, -1.0, v151
    v_mul_f32 v47, -1.0, v151
    v_mul_f32 v48, -1.0, v151
    v_mul_f32 v49, -1.0, v151
    v_mul_f32 v50, -1.0, v151
    v_mul_f32 v51, -1.0, v151
    v_mul_f32 v52, -1.0, v152
    v_mul_f32 v53, -1.0, v152
    v_mul_f32 v54, -1.0, v152
    v_mul_f32 v55, -1.0, v152
    v_mul_f32 v56, -1.0, v152
    v_mul_f32 v57, -1.0, v152
    v_mul_f32 v58, -1.0, v152
    v_mul_f32 v59, -1.0, v152
    v_mul_f32 v60, -1.0, v152
    v_mul_f32 v61, -1.0, v152
    v_mul_f32 v62, -1.0, v152
    v_mul_f32 v63, -1.0, v152
    v_mul_f32 v64, -1.0, v152
    v_mul_f32 v65, -1.0, v152
    v_mul_f32 v66, -1.0, v152
    v_mul_f32 v67, -1.0, v152
    s_mov_b32 s26, 0
    v_mov_b32 v108, 0
    v_mov_b32 v109, 0
    v_mov_b32 v110, 0
    v_mov_b32 v111, 0
    v_mov_b32 v112, 0
    v_mov_b32 v113, 0
    v_mov_b32 v114, 0
    v_mov_b32 v115, 0
    v_mov_b32 v28, 0
    v_mov_b32 v29, 0
    v_mov_b32 v30, 0
    v_mov_b32 v31, 0
    v_mov_b32 v32, 0
    v_mov_b32 v33, 0
    v_mov_b32 v34, 0
    v_mov_b32 v35, 0
    v_mfma_f32_32x32x16_bf16 v[68:83], v[12:15], v[4:7], v[36:51]
    s_waitcnt lgkmcnt(0)
    s_nop 7
    s_nop 1
K2_LOOP:
    ds_read_b128 v[16:19], v148 offset:1024
    v_exp_f32 v68, v68
    v_exp_f32 v69, v69
    v_mfma_f32_32x32x16_bf16 v[84:99], v[12:15], v[8:11], v[52:67]
    v_exp_f32 v70, v70
    v_exp_f32 v71, v71
    v_exp_f32 v72, v72
    v_exp_f32 v73, v73
    v_mfma_f32_32x32x16_bf16 v[132:147], v[28:31], v[108:111], v[132:147]
    v_exp_f32 v74, v74
    v_exp_f32 v75, v75
    v_exp_f32 v76, v76
    v_exp_f32 v77, v77
    v_mfma_f32_32x32x16_bf16 v[132:147], v[32:35], v[112:115], v[132:147]
    ds_read_b128 v[28:31], v149 offset:1024
    ds_read_b128 v[32:35], v149 offset:1536
    v_exp_f32 v78, v78
    v_exp_f32 v79, v79
    v_exp_f32 v80, v80
    v_exp_f32 v81, v81
    v_exp_f32 v82, v82
    v_exp_f32 v83, v83
    v_cvt_pk_bf16_f32 v100, v68, v69
    v_cvt_pk_bf16_f32 v101, v70, v71
    v_cvt_pk_bf16_f32 v102, v72, v73
    v_cvt_pk_bf16_f32 v103, v74, v75
    v_cvt_pk_bf16_f32 v104, v76, v77
    v_cvt_pk_bf16_f32 v105, v78, v79
    v_cvt_pk_bf16_f32 v106, v80, v81
    v_cvt_pk_bf16_f32 v107, v82, v83
    s_waitcnt lgkmcnt(2)
    v_exp_f32 v84, v84
    v_exp_f32 v85, v85
    v_mfma_f32_32x32x16_bf16 v[68:83], v[16:19], v[4:7], v[36:51]
    v_exp_f32 v86, v86
    v_exp_f32 v87, v87
    v_exp_f32 v88, v88
    v_exp_f32 v89, v89
    v_mfma_f32_32x32x16_bf16 v[116:131], v[20:23], v[100:103], v[116:131]
    v_exp_f32 v90, v90
    v_exp_f32 v91, v91
    v_exp_f32 v92, v92
    v_exp_f32 v93, v93
    v_mfma_f32_32x32x16_bf16 v[116:131], v[24:27], v[104:107], v[116:131]
    v_exp_f32 v94, v94
    v_exp_f32 v95, v95
    v_exp_f32 v96, v96
    v_exp_f32 v97, v97
    v_exp_f32 v98, v98
    v_exp_f32 v99, v99
    v_cvt_pk_bf16_f32 v108, v84, v85
    v_cvt_pk_bf16_f32 v109, v86, v87
    v_cvt_pk_bf16_f32 v110, v88, v89
    v_cvt_pk_bf16_f32 v111, v90, v91
    v_cvt_pk_bf16_f32 v112, v92, v93
    v_cvt_pk_bf16_f32 v113, v94, v95
    v_cvt_pk_bf16_f32 v114, v96, v97
    v_cvt_pk_bf16_f32 v115, v98, v99
    ds_read_b128 v[12:15], v148 offset:2048
    v_exp_f32 v68, v68
    v_exp_f32 v69, v69
    v_mfma_f32_32x32x16_bf16 v[84:99], v[16:19], v[8:11], v[52:67]
    v_exp_f32 v70, v70
    v_exp_f32 v71, v71
    v_exp_f32 v72, v72
    v_exp_f32 v73, v73
    v_mfma_f32_32x32x16_bf16 v[132:147], v[20:23], v[108:111], v[132:147]
    v_exp_f32 v74, v74
    v_exp_f32 v75, v75
    v_exp_f32 v76, v76
    v_exp_f32 v77, v77
    v_mfma_f32_32x32x16_bf16 v[132:147], v[24:27], v[112:115], v[132:147]
    ds_read_b128 v[20:23], v149 offset:2048
    ds_read_b128 v[24:27], v149 offset:2560
    v_exp_f32 v78, v78
    v_exp_f32 v79, v79
    v_exp_f32 v80, v80
    v_exp_f32 v81, v81
    v_exp_f32 v82, v82
    v_exp_f32 v83, v83
    v_cvt_pk_bf16_f32 v100, v68, v69
    v_cvt_pk_bf16_f32 v101, v70, v71
    v_cvt_pk_bf16_f32 v102, v72, v73
    v_cvt_pk_bf16_f32 v103, v74, v75
    v_cvt_pk_bf16_f32 v104, v76, v77
    v_cvt_pk_bf16_f32 v105, v78, v79
    v_cvt_pk_bf16_f32 v106, v80, v81
    v_cvt_pk_bf16_f32 v107, v82, v83
    s_waitcnt lgkmcnt(2)
    v_exp_f32 v84, v84
    v_exp_f32 v85, v85
    v_mfma_f32_32x32x16_bf16 v[68:83], v[12:15], v[4:7], v[36:51]
    v_exp_f32 v86, v86
    v_exp_f32 v87, v87
    v_exp_f32 v88, v88
    v_exp_f32 v89, v89
    v_mfma_f32_32x32x16_bf16 v[116:131], v[28:31], v[100:103], v[116:131]
    v_exp_f32 v90, v90
    v_exp_f32 v91, v91
    v_exp_f32 v92, v92
    v_exp_f32 v93, v93
    v_mfma_f32_32x32x16_bf16 v[116:131], v[32:35], v[104:107], v[116:131]
    v_exp_f32 v94, v94
    v_exp_f32 v95, v95
    v_exp_f32 v96, v96
    v_exp_f32 v97, v97
    v_exp_f32 v98, v98
    v_exp_f32 v99, v99
    v_cvt_pk_bf16_f32 v108, v84, v85
    v_cvt_pk_bf16_f32 v109, v86, v87
    v_cvt_pk_bf16_f32 v110, v88, v89
    v_cvt_pk_bf16_f32 v111, v90, v91
    v_cvt_pk_bf16_f32 v112, v92, v93
    v_cvt_pk_bf16_f32 v113, v94, v95
    v_cvt_pk_bf16_f32 v114, v96, v97
    v_cvt_pk_bf16_f32 v115, v98, v99
    ds_read_b128 v[16:19], v148 offset:3072
    v_exp_f32 v68, v68
    v_exp_f32 v69, v69
    v_mfma_f32_32x32x16_bf16 v[84:99], v[12:15], v[8:11], v[52:67]
    v_exp_f32 v70, v70
    v_exp_f32 v71, v71
    v_exp_f32 v72, v72
    v_exp_f32 v73, v73
    v_mfma_f32_32x32x16_bf16 v[132:147], v[28:31], v[108:111], v[132:147]
    v_exp_f32 v74, v74
    v_exp_f32 v75, v75
    v_exp_f32 v76, v76
    v_exp_f32 v77, v77
    v_mfma_f32_32x32x16_bf16 v[132:147], v[32:35], v[112:115], v[132:147]
    ds_read_b128 v[28:31], v149 offset:3072
    ds_read_b128 v[32:35], v149 offset:3584
    v_exp_f32 v78, v78
    v_exp_f32 v79, v79
    v_exp_f32 v80, v80
    v_exp_f32 v81, v81
    v_exp_f32 v82, v82
    v_exp_f32 v83, v83
    v_cvt_pk_bf16_f32 v100, v68, v69
    v_cvt_pk_bf16_f32 v101, v70, v71
    v_cvt_pk_bf16_f32 v102, v72, v73
    v_cvt_pk_bf16_f32 v103, v74, v75
    v_cvt_pk_bf16_f32 v104, v76, v77
    v_cvt_pk_bf16_f32 v105, v78, v79
    v_cvt_pk_bf16_f32 v106, v80, v81
    v_cvt_pk_bf16_f32 v107, v82, v83
    s_waitcnt lgkmcnt(2)
    v_exp_f32 v84, v84
    v_exp_f32 v85, v85
    v_mfma_f32_32x32x16_bf16 v[68:83], v[16:19], v[4:7], v[36:51]
    v_exp_f32 v86, v86
    v_exp_f32 v87, v87
    v_exp_f32 v88, v88
    v_exp_f32 v89, v89
    v_mfma_f32_32x32x16_bf16 v[116:131], v[20:23], v[100:103], v[116:131]
    v_exp_f32 v90, v90
    v_exp_f32 v91, v91
    v_exp_f32 v92, v92
    v_exp_f32 v93, v93
    v_mfma_f32_32x32x16_bf16 v[116:131], v[24:27], v[104:107], v[116:131]
    v_exp_f32 v94, v94
    v_exp_f32 v95, v95
    v_exp_f32 v96, v96
    v_exp_f32 v97, v97
    v_exp_f32 v98, v98
    v_exp_f32 v99, v99
    v_cvt_pk_bf16_f32 v108, v84, v85
    v_cvt_pk_bf16_f32 v109, v86, v87
    v_cvt_pk_bf16_f32 v110, v88, v89
    v_cvt_pk_bf16_f32 v111, v90, v91
    v_cvt_pk_bf16_f32 v112, v92, v93
    v_cvt_pk_bf16_f32 v113, v94, v95
    v_cvt_pk_bf16_f32 v114, v96, v97
    v_cvt_pk_bf16_f32 v115, v98, v99
    ds_read_b128 v[12:15], v148 offset:4096
    v_exp_f32 v68, v68
    v_exp_f32 v69, v69
    v_mfma_f32_32x32x16_bf16 v[84:99], v[16:19], v[8:11], v[52:67]
    v_exp_f32 v70, v70
    v_exp_f32 v71, v71
    v_exp_f32 v72, v72
    v_exp_f32 v73, v73
    v_mfma_f32_32x32x16_bf16 v[132:147], v[20:23], v[108:111], v[132:147]
    v_exp_f32 v74, v74
    v_exp_f32 v75, v75
    v_exp_f32 v76, v76
    v_exp_f32 v77, v77
    v_mfma_f32_32x32x16_bf16 v[132:147], v[24:27], v[112:115], v[132:147]
    ds_read_b128 v[20:23], v149 offset:4096
    ds_read_b128 v[24:27], v149 offset:4608
    v_exp_f32 v78, v78
    v_exp_f32 v79, v79
    v_exp_f32 v80, v80
    v_exp_f32 v81, v81
    v_exp_f32 v82, v82
    v_exp_f32 v83, v83
    v_cvt_pk_bf16_f32 v100, v68, v69
    v_cvt_pk_bf16_f32 v101, v70, v71
    v_cvt_pk_bf16_f32 v102, v72, v73
    v_cvt_pk_bf16_f32 v103, v74, v75
    v_cvt_pk_bf16_f32 v104, v76, v77
    v_cvt_pk_bf16_f32 v105, v78, v79
    v_cvt_pk_bf16_f32 v106, v80, v81
    v_cvt_pk_bf16_f32 v107, v82, v83
    s_waitcnt lgkmcnt(2)
    v_exp_f32 v84, v84
    v_exp_f32 v85, v85
    v_mfma_f32_32x32x16_bf16 v[68:83], v[12:15], v[4:7], v[36:51]
    v_exp_f32 v86, v86
    v_exp_f32 v87, v87
    v_exp_f32 v88, v88
    v_exp_f32 v89, v89
    v_mfma_f32_32x32x16_bf16 v[116:131], v[28:31], v[100:103], v[116:131]
    v_exp_f32 v90, v90
    v_exp_f32 v91, v91
    v_exp_f32 v92, v92
    v_exp_f32 v93, v93
    v_mfma_f32_32x32x16_bf16 v[116:131], v[32:35], v[104:107], v[116:131]
    v_exp_f32 v94, v94
    v_exp_f32 v95, v95
    v_exp_f32 v96, v96
    v_exp_f32 v97, v97
    v_exp_f32 v98, v98
    v_exp_f32 v99, v99
    v_cvt_pk_bf16_f32 v108, v84, v85
    v_cvt_pk_bf16_f32 v109, v86, v87
    v_cvt_pk_bf16_f32 v110, v88, v89
    v_cvt_pk_bf16_f32 v111, v90, v91
    v_cvt_pk_bf16_f32 v112, v92, v93
    v_cvt_pk_bf16_f32 v113, v94, v95
    v_cvt_pk_bf16_f32 v114, v96, v97
    v_cvt_pk_bf16_f32 v115, v98, v99
    ds_read_b128 v[16:19], v148 offset:5120
    v_exp_f32 v68, v68
    v_exp_f32 v69, v69
    v_mfma_f32_32x32x16_bf16 v[84:99], v[12:15], v[8:11], v[52:67]
    v_exp_f32 v70, v70
    v_exp_f32 v71, v71
    v_exp_f32 v72, v72
    v_exp_f32 v73, v73
    v_mfma_f32_32x32x16_bf16 v[132:147], v[28:31], v[108:111], v[132:147]
    v_exp_f32 v74, v74
    v_exp_f32 v75, v75
    v_exp_f32 v76, v76
    v_exp_f32 v77, v77
    v_mfma_f32_32x32x16_bf16 v[132:147], v[32:35], v[112:115], v[132:147]
    ds_read_b128 v[28:31], v149 offset:5120
    ds_read_b128 v[32:35], v149 offset:5632
    v_exp_f32 v78, v78
    v_exp_f32 v79, v79
    v_exp_f32 v80, v80
    v_exp_f32 v81, v81
    v_exp_f32 v82, v82
    v_exp_f32 v83, v83
    v_cvt_pk_bf16_f32 v100, v68, v69
    v_cvt_pk_bf16_f32 v101, v70, v71
    v_cvt_pk_bf16_f32 v102, v72, v73
    v_cvt_pk_bf16_f32 v103, v74, v75
    v_cvt_pk_bf16_f32 v104, v76, v77
    v_cvt_pk_bf16_f32 v105, v78, v79
    v_cvt_pk_bf16_f32 v106, v80, v81
    v_cvt_pk_bf16_f32 v107, v82, v83
    s_waitcnt lgkmcnt(2)
    v_exp_f32 v84, v84
    v_exp_f32 v85, v85
    v_mfma_f32_32x32x16_bf16 v[68:83], v[16:19], v[4:7], v[36:51]
    v_exp_f32 v86, v86
    v_exp_f32 v87, v87
    v_exp_f32 v88, v88
    v_exp_f32 v89, v89
    v_mfma_f32_32x32x16_bf16 v[116:131], v[20:23], v[100:103], v[116:131]
    v_exp_f32 v90, v90
    v_exp_f32 v91, v91
    v_exp_f32 v92, v92
    v_exp_f32 v93, v93
    v_mfma_f32_32x32x16_bf16 v[116:131], v[24:27], v[104:107], v[116:131]
    v_exp_f32 v94, v94
    v_exp_f32 v95, v95
    v_exp_f32 v96, v96
    v_exp_f32 v97, v97
    v_exp_f32 v98, v98
    v_exp_f32 v99, v99
    v_cvt_pk_bf16_f32 v108, v84, v85
    v_cvt_pk_bf16_f32 v109, v86, v87
    v_cvt_pk_bf16_f32 v110, v88, v89
    v_cvt_pk_bf16_f32 v111, v90, v91
    v_cvt_pk_bf16_f32 v112, v92, v93
    v_cvt_pk_bf16_f32 v113, v94, v95
    v_cvt_pk_bf16_f32 v114, v96, v97
    v_cvt_pk_bf16_f32 v115, v98, v99
    ds_read_b128 v[12:15], v148 offset:6144
    v_exp_f32 v68, v68
    v_exp_f32 v69, v69
    v_mfma_f32_32x32x16_bf16 v[84:99], v[16:19], v[8:11], v[52:67]
    v_exp_f32 v70, v70
    v_exp_f32 v71, v71
    v_exp_f32 v72, v72
    v_exp_f32 v73, v73
    v_mfma_f32_32x32x16_bf16 v[132:147], v[20:23], v[108:111], v[132:147]
    v_exp_f32 v74, v74
    v_exp_f32 v75, v75
    v_exp_f32 v76, v76
    v_exp_f32 v77, v77
    v_mfma_f32_32x32x16_bf16 v[132:147], v[24:27], v[112:115], v[132:147]
    ds_read_b128 v[20:23], v149 offset:6144
    ds_read_b128 v[24:27], v149 offset:6656
    v_exp_f32 v78, v78
    v_exp_f32 v79, v79
    v_exp_f32 v80, v80
    v_exp_f32 v81, v81
    v_exp_f32 v82, v82
    v_exp_f32 v83, v83
    v_cvt_pk_bf16_f32 v100, v68, v69
    v_cvt_pk_bf16_f32 v101, v70, v71
    v_cvt_pk_bf16_f32 v102, v72, v73
    v_cvt_pk_bf16_f32 v103, v74, v75
    v_cvt_pk_bf16_f32 v104, v76, v77
    v_cvt_pk_bf16_f32 v105, v78, v79
    v_cvt_pk_bf16_f32 v106, v80, v81
    v_cvt_pk_bf16_f32 v107, v82, v83
    s_waitcnt lgkmcnt(2)
    v_exp_f32 v84, v84
    v_exp_f32 v85, v85
    v_mfma_f32_32x32x16_bf16 v[68:83], v[12:15], v[4:7], v[36:51]
    v_exp_f32 v86, v86
    v_exp_f32 v87, v87
    v_exp_f32 v88, v88
    v_exp_f32 v89, v89
    v_mfma_f32_32x32x16_bf16 v[116:131], v[28:31], v[100:103], v[116:131]
    v_exp_f32 v90, v90
    v_exp_f32 v91, v91
    v_exp_f32 v92, v92
    v_exp_f32 v93, v93
    v_mfma_f32_32x32x16_bf16 v[116:131], v[32:35], v[104:107], v[116:131]
    v_exp_f32 v94, v94
    v_exp_f32 v95, v95
    v_exp_f32 v96, v96
    v_exp_f32 v97, v97
    v_exp_f32 v98, v98
    v_exp_f32 v99, v99
    v_cvt_pk_bf16_f32 v108, v84, v85
    v_cvt_pk_bf16_f32 v109, v86, v87
    v_cvt_pk_bf16_f32 v110, v88, v89
    v_cvt_pk_bf16_f32 v111, v90, v91
    v_cvt_pk_bf16_f32 v112, v92, v93
    v_cvt_pk_bf16_f32 v113, v94, v95
    v_cvt_pk_bf16_f32 v114, v96, v97
    v_cvt_pk_bf16_f32 v115, v98, v99
    ds_read_b128 v[16:19], v148 offset:7168
    v_exp_f32 v68, v68
    v_exp_f32 v69, v69
    v_mfma_f32_32x32x16_bf16 v[84:99], v[12:15], v[8:11], v[52:67]
    v_exp_f32 v70, v70
    v_exp_f32 v71, v71
    v_exp_f32 v72, v72
    v_exp_f32 v73, v73
    v_mfma_f32_32x32x16_bf16 v[132:147], v[28:31], v[108:111], v[132:147]
    v_exp_f32 v74, v74
    v_exp_f32 v75, v75
    v_exp_f32 v76, v76
    v_exp_f32 v77, v77
    v_mfma_f32_32x32x16_bf16 v[132:147], v[32:35], v[112:115], v[132:147]
    ds_read_b128 v[28:31], v149 offset:7168
    ds_read_b128 v[32:35], v149 offset:7680
    v_exp_f32 v78, v78
    v_exp_f32 v79, v79
    v_exp_f32 v80, v80
    v_exp_f32 v81, v81
    v_exp_f32 v82, v82
    v_exp_f32 v83, v83
    v_cvt_pk_bf16_f32 v100, v68, v69
    v_cvt_pk_bf16_f32 v101, v70, v71
    v_cvt_pk_bf16_f32 v102, v72, v73
    v_cvt_pk_bf16_f32 v103, v74, v75
    v_cvt_pk_bf16_f32 v104, v76, v77
    v_cvt_pk_bf16_f32 v105, v78, v79
    v_cvt_pk_bf16_f32 v106, v80, v81
    v_cvt_pk_bf16_f32 v107, v82, v83
    s_waitcnt lgkmcnt(2)
    v_exp_f32 v84, v84
    v_exp_f32 v85, v85
    v_mfma_f32_32x32x16_bf16 v[68:83], v[16:19], v[4:7], v[36:51]
    v_exp_f32 v86, v86
    v_exp_f32 v87, v87
    v_exp_f32 v88, v88
    v_exp_f32 v89, v89
    v_mfma_f32_32x32x16_bf16 v[116:131], v[20:23], v[100:103], v[116:131]
    v_exp_f32 v90, v90
    v_exp_f32 v91, v91
    v_exp_f32 v92, v92
    v_exp_f32 v93, v93
    v_mfma_f32_32x32x16_bf16 v[116:131], v[24:27], v[104:107], v[116:131]
    v_exp_f32 v94, v94
    v_exp_f32 v95, v95
    v_exp_f32 v96, v96
    v_exp_f32 v97, v97
    v_exp_f32 v98, v98
    v_exp_f32 v99, v99
    v_cvt_pk_bf16_f32 v108, v84, v85
    v_cvt_pk_bf16_f32 v109, v86, v87
    v_cvt_pk_bf16_f32 v110, v88, v89
    v_cvt_pk_bf16_f32 v111, v90, v91
    v_cvt_pk_bf16_f32 v112, v92, v93
    v_cvt_pk_bf16_f32 v113, v94, v95
    v_cvt_pk_bf16_f32 v114, v96, v97
    v_cvt_pk_bf16_f32 v115, v98, v99
    s_or_b32 s54, s26, s27
    s_cmp_eq_u32 s54, 0
    s_cbranch_scc0 K2_NB2
    s_waitcnt vmcnt(0)
    s_barrier
    s_cmp_lt_u32 s48, 4
    s_cbranch_scc0 FZ_NPH
    v_mov_b32 v161, 140288
    v_mov_b32 v162, 1
    v_mov_b32 v163, 0
    s_mov_b64 exec, 1
    ds_read_b32 v164, v161
    s_waitcnt vmcnt(0)
    ds_add_rtn_u32 v162, v161, v162 offset:16
    s_waitcnt lgkmcnt(0)
    v_readfirstlane_b32 s54, v162
    s_nop 1
    s_cmp_eq_u32 s54, 3
    s_cbranch_scc0 FZ_PHx
    buffer_store_dword v164, v163, s[28:31], s94 offen sc1
FZ_PHx:
    s_mov_b64 exec, -1
FZ_NPH:
K2_NB2:
    ds_read_b128 v[12:15], v148 offset:8192
    v_exp_f32 v68, v68
    v_exp_f32 v69, v69
    v_mfma_f32_32x32x16_bf16 v[84:99], v[16:19], v[8:11], v[52:67]
    v_exp_f32 v70, v70
    v_exp_f32 v71, v71
    v_exp_f32 v72, v72
    v_exp_f32 v73, v73
    v_mfma_f32_32x32x16_bf16 v[132:147], v[20:23], v[108:111], v[132:147]
    v_exp_f32 v74, v74
    v_exp_f32 v75, v75
    v_exp_f32 v76, v76
    v_exp_f32 v77, v77
    v_mfma_f32_32x32x16_bf16 v[132:147], v[24:27], v[112:115], v[132:147]
    ds_read_b128 v[20:23], v149 offset:8192
    ds_read_b128 v[24:27], v149 offset:8704
    v_exp_f32 v78, v78
    v_exp_f32 v79, v79
    v_exp_f32 v80, v80
    v_exp_f32 v81, v81
    v_exp_f32 v82, v82
    v_exp_f32 v83, v83
    v_cvt_pk_bf16_f32 v100, v68, v69
    v_cvt_pk_bf16_f32 v101, v70, v71
    v_cvt_pk_bf16_f32 v102, v72, v73
    v_cvt_pk_bf16_f32 v103, v74, v75
    v_cvt_pk_bf16_f32 v104, v76, v77
    v_cvt_pk_bf16_f32 v105, v78, v79
    v_cvt_pk_bf16_f32 v106, v80, v81
    v_cvt_pk_bf16_f32 v107, v82, v83
    s_waitcnt lgkmcnt(2)
    v_exp_f32 v84, v84
    v_exp_f32 v85, v85
    v_mfma_f32_32x32x16_bf16 v[68:83], v[12:15], v[4:7], v[36:51]
    v_exp_f32 v86, v86
    v_exp_f32 v87, v87
    v_exp_f32 v88, v88
    v_exp_f32 v89, v89
    v_mfma_f32_32x32x16_bf16 v[116:131], v[28:31], v[100:103], v[116:131]
    v_exp_f32 v90, v90
    v_exp_f32 v91, v91
    v_exp_f32 v92, v92
    v_exp_f32 v93, v93
    v_mfma_f32_32x32x16_bf16 v[116:131], v[32:35], v[104:107], v[116:131]
    v_add_u32 v148, 8192, v148
    v_add_u32 v149, v150, v149
    v_exp_f32 v94, v94
    v_exp_f32 v95, v95
    v_exp_f32 v96, v96
    v_exp_f32 v97, v97
    v_exp_f32 v98, v98
    v_exp_f32 v99, v99
    v_cvt_pk_bf16_f32 v108, v84, v85
    v_cvt_pk_bf16_f32 v109, v86, v87
    v_cvt_pk_bf16_f32 v110, v88, v89
    v_cvt_pk_bf16_f32 v111, v90, v91
    v_cvt_pk_bf16_f32 v112, v92, v93
    v_cvt_pk_bf16_f32 v113, v94, v95
    v_cvt_pk_bf16_f32 v114, v96, v97
    v_cvt_pk_bf16_f32 v115, v98, v99
    s_add_u32 s26, s26, 1
    s_cmp_lt_u32 s26, 4
    s_cbranch_scc1 K2_LOOP
    s_waitcnt lgkmcnt(0)
    v_mfma_f32_32x32x16_bf16 v[132:147], v[28:31], v[108:111], v[132:147]
    v_mfma_f32_32x32x16_bf16 v[132:147], v[32:35], v[112:115], v[132:147]
    s_cmp_eq_u32 s27, 0
    s_cbranch_scc0 K2_DONE
    s_nop 7
    s_nop 7
    v_mov_b32 v153, 0x5f800000
    v_cmp_nle_f32 vcc, v124, v153
    v_cmp_nle_f32 s[54:55], v140, v153
    s_nop 0
    s_or_b64 vcc, vcc, s[54:55]
    s_cbranch_vccz K2_DONE
    s_mov_b32 s27, 1
    v_subrev_u32 v148, 0x8000, v148
    v_lshlrev_b32 v153, 2, v150
    v_sub_u32 v149, v149, v153
    v_mov_b32 v151, 0xff800000
    v_mov_b32 v152, 0xff800000
    v_mov_b32 v155, v148
    s_mov_b32 s26, 0
K2_FB:
    ds_read_b128 v[16:19], v155
    v_add_u32 v155, 0x400, v155
    s_waitcnt lgkmcnt(0)
    v_mfma_f32_32x32x16_bf16 v[68:83], v[16:19], v[4:7], 0
    v_mfma_f32_32x32x16_bf16 v[84:99], v[16:19], v[8:11], 0
    s_nop 7
    s_nop 3
    v_max3_f32 v151, v151, v68, v69
    v_max3_f32 v151, v151, v70, v71
    v_max3_f32 v151, v151, v72, v73
    v_max3_f32 v151, v151, v74, v75
    v_max3_f32 v151, v151, v76, v77
    v_max3_f32 v151, v151, v78, v79
    v_max3_f32 v151, v151, v80, v81
    v_max3_f32 v151, v151, v82, v83
    s_nop 7
    v_max3_f32 v152, v152, v84, v85
    v_max3_f32 v152, v152, v86, v87
    v_max3_f32 v152, v152, v88, v89
    v_max3_f32 v152, v152, v90, v91
    v_max3_f32 v152, v152, v92, v93
    v_max3_f32 v152, v152, v94, v95
    v_max3_f32 v152, v152, v96, v97
    v_max3_f32 v152, v152, v98, v99
    s_add_u32 s26, s26, 1
    s_cmp_lt_u32 s26, 32
    s_cbranch_scc1 K2_FB
    v_mov_b32 v116, 0
    v_mov_b32 v117, 0
    v_mov_b32 v118, 0
    v_mov_b32 v119, 0
    v_mov_b32 v120, 0
    v_mov_b32 v121, 0
    v_mov_b32 v122, 0
    v_mov_b32 v123, 0
    v_mov_b32 v124, 0
    v_mov_b32 v125, 0
    v_mov_b32 v126, 0
    v_mov_b32 v127, 0
    v_mov_b32 v128, 0
    v_mov_b32 v129, 0
    v_mov_b32 v130, 0
    v_mov_b32 v131, 0
    v_mov_b32 v132, 0
    v_mov_b32 v133, 0
    v_mov_b32 v134, 0
    v_mov_b32 v135, 0
    v_mov_b32 v136, 0
    v_mov_b32 v137, 0
    v_mov_b32 v138, 0
    v_mov_b32 v139, 0
    v_mov_b32 v140, 0
    v_mov_b32 v141, 0
    v_mov_b32 v142, 0
    v_mov_b32 v143, 0
    v_mov_b32 v144, 0
    v_mov_b32 v145, 0
    v_mov_b32 v146, 0
    v_mov_b32 v147, 0
    ds_read_b128 v[12:15], v148
    ds_read_b128 v[20:23], v149
    ds_read_b128 v[24:27], v149 offset:512
    s_waitcnt lgkmcnt(0)
    s_branch K2_SETM
K2_DONE:
    s_nop 7
    s_nop 7
    s_barrier
    s_mul_i32 s54, s48, 2560
    v_add_u32 v153, s54, v2
    v_lshlrev_b32 v154, 3, v1
    v_add_u32 v154, s54, v154
    s_xor_b32 s55, s48, 4
    s_mul_i32 s55, s55, 2560
    v_add_u32 v155, s55, v2
    v_lshlrev_b32 v156, 3, v1
    v_add_u32 v156, s55, v156
    s_lshl_b32 s56, s59, 3
    s_lshl_b32 s57, s60, 1
    s_add_u32 s56, s56, s57
    s_add_u32 s56, s56, s61
    s_lshl_b32 s56, s56, 5
    s_add_u32 s56, s56, s58
    s_lshl_b32 s56, s56, 10
    s_add_u32 s56, s56, 6291456
    s_cmp_eq_u32 s61, 0
    s_cbranch_scc0 K2_FIN1
    ds_write_b128 v153, v[132:135] offset:0
    ds_write_b128 v153, v[136:139] offset:1024
    v_mov_b32 v158, v140
    v_mov_b32 v159, v152
    ds_write_b64 v154, v[158:159] offset:2048
    s_waitcnt lgkmcnt(0)
    s_barrier
    ds_read_b64 v[76:77], v156 offset:2048
    ds_read_b128 v[68:71], v155 offset:0
    ds_read_b128 v[72:75], v155 offset:1024
    s_waitcnt lgkmcnt(2)
    v_max_f32 v160, v151, v77
    v_sub_f32 v161, v151, v160
    v_sub_f32 v162, v77, v160
    v_exp_f32 v161, v161
    v_exp_f32 v162, v162
    s_nop 0
    v_mul_f32 v163, v124, v161
    v_fmac_f32 v163, v76, v162
    v_rcp_f32 v163, v163
    s_nop 0
    v_mul_f32 v161, v161, v163
    v_mul_f32 v162, v162, v163
    s_waitcnt lgkmcnt(0)
    v_mul_f32 v116, v116, v161
    v_mul_f32 v117, v117, v161
    v_mul_f32 v118, v118, v161
    v_mul_f32 v119, v119, v161
    v_mul_f32 v120, v120, v161
    v_mul_f32 v121, v121, v161
    v_mul_f32 v122, v122, v161
    v_mul_f32 v123, v123, v161
    v_fmac_f32 v116, v68, v162
    v_fmac_f32 v117, v69, v162
    v_fmac_f32 v118, v70, v162
    v_fmac_f32 v119, v71, v162
    v_fmac_f32 v120, v72, v162
    v_fmac_f32 v121, v73, v162
    v_fmac_f32 v122, v74, v162
    v_fmac_f32 v123, v75, v162
    v_cvt_pk_bf16_f32 v100, v116, v117
    v_cvt_pk_bf16_f32 v101, v118, v119
    v_cvt_pk_bf16_f32 v102, v120, v121
    v_cvt_pk_bf16_f32 v103, v122, v123
    buffer_store_dwordx4 v[100:103], v2, s[28:31], s56 offen sc1
    s_branch K2_PUB
K2_FIN1:
    ds_write_b128 v153, v[116:119] offset:0
    ds_write_b128 v153, v[120:123] offset:1024
    v_mov_b32 v158, v124
    v_mov_b32 v159, v151
    ds_write_b64 v154, v[158:159] offset:2048
    s_waitcnt lgkmcnt(0)
    s_barrier
    ds_read_b64 v[76:77], v156 offset:2048
    ds_read_b128 v[68:71], v155 offset:0
    ds_read_b128 v[72:75], v155 offset:1024
    s_waitcnt lgkmcnt(2)
    v_max_f32 v160, v152, v77
    v_sub_f32 v161, v152, v160
    v_sub_f32 v162, v77, v160
    v_exp_f32 v161, v161
    v_exp_f32 v162, v162
    s_nop 0
    v_mul_f32 v163, v140, v161
    v_fmac_f32 v163, v76, v162
    v_rcp_f32 v163, v163
    s_nop 0
    v_mul_f32 v161, v161, v163
    v_mul_f32 v162, v162, v163
    s_waitcnt lgkmcnt(0)
    v_mul_f32 v132, v132, v161
    v_mul_f32 v133, v133, v161
    v_mul_f32 v134, v134, v161
    v_mul_f32 v135, v135, v161
    v_mul_f32 v136, v136, v161
    v_mul_f32 v137, v137, v161
    v_mul_f32 v138, v138, v161
    v_mul_f32 v139, v139, v161
    v_fmac_f32 v132, v68, v162
    v_fmac_f32 v133, v69, v162
    v_fmac_f32 v134, v70, v162
    v_fmac_f32 v135, v71, v162
    v_fmac_f32 v136, v72, v162
    v_fmac_f32 v137, v73, v162
    v_fmac_f32 v138, v74, v162
    v_fmac_f32 v139, v75, v162
    v_cvt_pk_bf16_f32 v100, v132, v133
    v_cvt_pk_bf16_f32 v101, v134, v135
    v_cvt_pk_bf16_f32 v102, v136, v137
    v_cvt_pk_bf16_f32 v103, v138, v139
    buffer_store_dwordx4 v[100:103], v2, s[28:31], s56 offen sc1
    s_branch K2_PUB
K2_PUB:
    s_lshl_b32 s56, s59, 5
    s_add_u32 s56, s56, s58
    s_mul_i32 s56, s56, 16
    s_add_u32 s56, s56, 14680064
    v_mov_b32 v153, 140288
    v_mov_b32 v154, 1
    v_mov_b32 v157, 0
    s_mov_b64 exec, 1
    ds_read_b32 v155, v153
    s_waitcnt vmcnt(0)
    ds_add_rtn_u32 v156, v153, v154 offset:4
    s_waitcnt lgkmcnt(0)
    v_readfirstlane_b32 s54, v156
    s_nop 1
    s_cmp_eq_u32 s54, 7
    s_cbranch_scc0 K2_PUBX
    buffer_store_dword v155, v157, s[28:31], s56 offen sc1
K2_PUBX:
    s_mov_b64 exec, -1
    s_endpgm
PB_LD:
    v_lshlrev_b32 v20, 9, v19
    v_add_u32 v7, v18, v20
    s_lshl_b32 s54, s49, 12
    v_add_u32 v7, s54, v7
    v_lshlrev_b32 v21, 8, v19
    v_add_u32 v16, v18, v21
    s_lshl_b32 s54, s49, 11
    s_add_u32 s54, s54, 144512
    v_add_u32 v16, s54, v16
    v_lshrrev_b32 v20, 4, v1
    v_and_b32 v21, 7, v1
    v_xor_b32 v21, v21, v20
    v_lshlrev_b32 v21, 4, v21
    v_lshrrev_b32 v20, 3, v1
    v_lshlrev_b32 v20, 10, v20
    v_add_u32 v3, v20, v21
    v_xor_b32 v4, 64, v3
    v_lshrrev_b32 v20, 2, v1
    v_and_b32 v21, 3, v1
    v_lshlrev_b32 v21, 4, v21
    v_mul_u32_u24 v5, 3072, v20
    v_add_u32 v5, v5, v21
    v_mul_u32_u24 v6, 3584, v20
    v_add_u32 v6, v6, v21
    v_lshlrev_b32 v17, 10, v20
    v_add_u32 v17, v17, v21
    s_lshl_b32 s58, s50, 17
    s_lshl_b32 s54, s49, 15
    s_add_u32 s58, s58, s54
    s_lshl_b32 s59, s51, 6
    s_mul_i32 s54, s49, 49152
    s_add_u32 s59, s59, s54
    s_lshl_b32 s60, s52, 6
    s_mul_i32 s54, s49, 57344
    s_add_u32 s60, s60, s54
    s_add_u32 s55, s52, s49
    s_min_u32 s55, s55, 55
    s_lshl_b32 s55, s55, 6
    v_and_b32 v8, 31, v1
    v_lshlrev_b32 v20, 1, v8
    v_mov_b32 v10, 0
    v_mov_b32 v11, 0
    v_mov_b32 v12, 0
    v_mov_b32 v13, 0
    s_mov_b32 s61, 0
    s_waitcnt lgkmcnt(0)
    s_mov_b32 s32, s4
    s_mov_b32 s33, s5
    s_mov_b32 s34, 2097152
    s_mov_b32 s35, 0x20000
    s_mov_b32 s36, s6
    s_mov_b32 s37, s7
    s_mov_b32 s38, 1572864
    s_mov_b32 s39, 0x20000
    s_mov_b32 s40, s12
    s_mov_b32 s41, s13
    s_mov_b32 s42, 1835008
    s_mov_b32 s43, 0x20000
    s_mov_b32 s44, s14
    s_mov_b32 s45, s15
    s_mov_b32 s46, 3584
    s_mov_b32 s47, 0x20000
    s_mov_b32 s28, s24
    s_mov_b32 s29, s25
    s_mov_b32 s30, 25165824
    s_mov_b32 s31, 0x20000
    v_lshlrev_b32 v20, 1, v8
    buffer_load_ushort v9, v20, s[44:47], s55 offen
    s_lshl_b32 s56, s49, 12
    s_add_u32 s56, s56, s61
    s_add_u32 m0, s56, 0
    s_add_u32 s54, s58, 0
    buffer_load_dwordx4 v3, s[32:35], s54 offen lds
    s_add_u32 m0, s56, 1024
    s_add_u32 s54, s58, 8192
    buffer_load_dwordx4 v4, s[32:35], s54 offen lds
    s_add_u32 m0, s56, 2048
    s_add_u32 s54, s58, 16384
    buffer_load_dwordx4 v3, s[32:35], s54 offen lds
    s_add_u32 m0, s56, 3072
    s_add_u32 s54, s58, 24576
    buffer_load_dwordx4 v4, s[32:35], s54 offen lds
    s_lshl_b32 s56, s49, 10
    s_add_u32 s56, s56, s61
    s_add_u32 m0, s56, 16384
    s_add_u32 s54, s59, 0
    buffer_load_dwordx4 v5, s[36:39], s54 offen lds
    s_add_u32 m0, s56, 20480
    s_add_u32 s54, s59, 1024
    buffer_load_dwordx4 v5, s[36:39], s54 offen lds
    s_add_u32 m0, s56, 24576
    s_add_u32 s54, s59, 2048
    buffer_load_dwordx4 v5, s[36:39], s54 offen lds
    s_add_u32 m0, s56, 28672
    s_add_u32 s54, s60, 0
    buffer_load_dwordx4 v6, s[40:43], s54 offen lds
    s_add_u32 m0, s56, 32768
    s_add_u32 s54, s60, 64
    buffer_load_dwordx4 v6, s[40:43], s54 offen lds
    s_add_u32 m0, s56, 36864
    s_add_u32 s54, s60, 128
    buffer_load_dwordx4 v6, s[40:43], s54 offen lds
    s_bitcmp1_b32 s51, 0
    s_cbranch_scc1 PB_LD_n4_1
    s_add_u32 m0, s56, 40960
    s_add_u32 s54, s60, 192
    buffer_load_dwordx4 v6, s[40:43], s54 offen lds
PB_LD_n4_1:
    s_add_u32 s58, s58, 128
    s_add_u32 s59, s59, 196608
    s_add_u32 s60, s60, 229376
    s_add_u32 s61, s61, 45056
    s_cmp_eq_u32 s61, 135168
    s_cselect_b32 s61, 0, s61
    s_lshl_b32 s56, s49, 12
    s_add_u32 s56, s56, s61
    s_add_u32 m0, s56, 0
    s_add_u32 s54, s58, 0
    buffer_load_dwordx4 v3, s[32:35], s54 offen lds
    s_add_u32 m0, s56, 1024
    s_add_u32 s54, s58, 8192
    buffer_load_dwordx4 v4, s[32:35], s54 offen lds
    s_add_u32 m0, s56, 2048
    s_add_u32 s54, s58, 16384
    buffer_load_dwordx4 v3, s[32:35], s54 offen lds
    s_add_u32 m0, s56, 3072
    s_add_u32 s54, s58, 24576
    buffer_load_dwordx4 v4, s[32:35], s54 offen lds
    s_lshl_b32 s56, s49, 10
    s_add_u32 s56, s56, s61
    s_add_u32 m0, s56, 16384
    s_add_u32 s54, s59, 0
    buffer_load_dwordx4 v5, s[36:39], s54 offen lds
    s_add_u32 m0, s56, 20480
    s_add_u32 s54, s59, 1024
    buffer_load_dwordx4 v5, s[36:39], s54 offen lds
    s_add_u32 m0, s56, 24576
    s_add_u32 s54, s59, 2048
    buffer_load_dwordx4 v5, s[36:39], s54 offen lds
    s_add_u32 m0, s56, 28672
    s_add_u32 s54, s60, 0
    buffer_load_dwordx4 v6, s[40:43], s54 offen lds
    s_add_u32 m0, s56, 32768
    s_add_u32 s54, s60, 64
    buffer_load_dwordx4 v6, s[40:43], s54 offen lds
    s_add_u32 m0, s56, 36864
    s_add_u32 s54, s60, 128
    buffer_load_dwordx4 v6, s[40:43], s54 offen lds
    s_bitcmp1_b32 s51, 0
    s_cbranch_scc1 PB_LD_n4_2
    s_add_u32 m0, s56, 40960
    s_add_u32 s54, s60, 192
    buffer_load_dwordx4 v6, s[40:43], s54 offen lds
PB_LD_n4_2:
    s_add_u32 s58, s58, 128
    s_add_u32 s59, s59, 196608
    s_add_u32 s60, s60, 229376
    s_add_u32 s61, s61, 45056
    s_cmp_eq_u32 s61, 135168
    s_cselect_b32 s61, 0, s61
    s_and_b32 s54, s2, 7
    s_lshl_b32 s54, s54, 2
    s_lshr_b32 s55, s2, 6
    s_add_u32 s57, s54, s55
    s_lshr_b32 s56, s2, 3
    s_and_b32 s56, s56, 7
    s_lshl_b32 s56, s56, 1
    s_mul_i32 s66, s57, 7
    s_lshl_b32 s54, s49, 1
    s_add_u32 s66, s66, s54
    s_and_b32 s54, s66, 1
    s_add_u32 s54, s54, s56
    s_lshr_b32 s55, s66, 1
    s_lshl_b32 s67, s55, 14
    s_mul_i32 s68, s54, 112
    s_add_u32 s68, s68, s55
    s_lshl_b32 s68, s68, 10
    s_add_u32 s68, s68, 10485760
    s_lshl_b32 s54, s54, 6
    s_add_u32 s67, s67, s54
    s_add_u32 s66, s66, 1
    s_and_b32 s54, s66, 1
    s_add_u32 s54, s54, s56
    s_lshr_b32 s55, s66, 1
    s_lshl_b32 s27, s55, 14
    s_mul_i32 s93, s54, 112
    s_add_u32 s93, s93, s55
    s_lshl_b32 s93, s93, 10
    s_add_u32 s93, s93, 10485760
    s_lshl_b32 s54, s54, 6
    s_add_u32 s27, s27, s54
    s_cmp_eq_u32 s49, 3
    s_cbranch_scc0 PB_LD_trs
    s_add_u32 s54, s56, 0
    s_lshl_b32 s27, s57, 14
    s_lshl_b32 s93, s54, 5
    s_add_u32 s93, s93, s57
    s_lshl_b32 s93, s93, 10
    s_add_u32 s93, s93, 12582912
    s_lshl_b32 s54, s54, 6
    s_add_u32 s27, s27, s54
    s_add_u32 s54, s56, 1
    s_lshl_b32 s69, s57, 14
    s_lshl_b32 s70, s54, 5
    s_add_u32 s70, s70, s57
    s_lshl_b32 s70, s70, 10
    s_add_u32 s70, s70, 12582912
    s_lshl_b32 s54, s54, 6
    s_add_u32 s69, s69, s54
PB_LD_trs:
    s_mov_b32 s26, 0
    s_mov_b32 s71, 0
PB_LD_LOOP:
    s_cmp_eq_u32 s26, 0
    s_cbranch_scc0 PB_LD_w1
    s_waitcnt vmcnt(10)
    s_branch PB_LD_wx
PB_LD_w1:
    s_cmp_lt_u32 s26, 6
    s_cbranch_scc0 PB_LD_w6
    s_waitcnt vmcnt(10)
    s_branch PB_LD_wx
PB_LD_w6:
    s_cmp_eq_u32 s26, 6
    s_cbranch_scc0 PB_LD_w7
    s_waitcnt vmcnt(12)
    s_branch PB_LD_wx
PB_LD_w7:
    s_waitcnt vmcnt(2)
PB_LD_wx:
    s_barrier
    s_cmp_lt_u32 s26, 6
    s_cbranch_scc0 PB_LD_noissue
    s_lshl_b32 s56, s49, 12
    s_add_u32 s56, s56, s61
    s_add_u32 m0, s56, 0
    s_add_u32 s54, s58, 0
    buffer_load_dwordx4 v3, s[32:35], s54 offen lds
    s_add_u32 m0, s56, 1024
    s_add_u32 s54, s58, 8192
    buffer_load_dwordx4 v4, s[32:35], s54 offen lds
    s_add_u32 m0, s56, 2048
    s_add_u32 s54, s58, 16384
    buffer_load_dwordx4 v3, s[32:35], s54 offen lds
    s_add_u32 m0, s56, 3072
    s_add_u32 s54, s58, 24576
    buffer_load_dwordx4 v4, s[32:35], s54 offen lds
    s_lshl_b32 s56, s49, 10
    s_add_u32 s56, s56, s61
    s_add_u32 m0, s56, 16384
    s_add_u32 s54, s59, 0
    buffer_load_dwordx4 v5, s[36:39], s54 offen lds
    s_add_u32 m0, s56, 20480
    s_add_u32 s54, s59, 1024
    buffer_load_dwordx4 v5, s[36:39], s54 offen lds
    s_add_u32 m0, s56, 24576
    s_add_u32 s54, s59, 2048
    buffer_load_dwordx4 v5, s[36:39], s54 offen lds
    s_add_u32 m0, s56, 28672
    s_add_u32 s54, s60, 0
    buffer_load_dwordx4 v6, s[40:43], s54 offen lds
    s_add_u32 m0, s56, 32768
    s_add_u32 s54, s60, 64
    buffer_load_dwordx4 v6, s[40:43], s54 offen lds
    s_add_u32 m0, s56, 36864
    s_add_u32 s54, s60, 128
    buffer_load_dwordx4 v6, s[40:43], s54 offen lds
    s_bitcmp1_b32 s51, 0
    s_cbranch_scc1 PB_LD_n4_3
    s_add_u32 m0, s56, 40960
    s_add_u32 s54, s60, 192
    buffer_load_dwordx4 v6, s[40:43], s54 offen lds
PB_LD_n4_3:
    s_add_u32 s58, s58, 128
    s_add_u32 s59, s59, 196608
    s_add_u32 s60, s60, 229376
    s_add_u32 s61, s61, 45056
    s_cmp_eq_u32 s61, 135168
    s_cselect_b32 s61, 0, s61
    s_cmp_eq_u32 s26, 5
    s_cbranch_scc0 PB_LD_noissue
    s_mov_b32 s44, s16
    s_mov_b32 s45, s17
    s_mov_b32 s46, 1835008
    s_mov_b32 s47, 0x20000
    s_lshl_b32 s54, s49, 11
    s_add_u32 m0, s54, 144512
    s_nop 0
    buffer_load_dwordx4 v17, s[44:47], s67 offen lds
    s_cmp_eq_u32 s49, 3
    s_cbranch_scc0 PB_LD_tr2
    s_mov_b32 s44, s8
    s_mov_b32 s45, s9
    s_mov_b32 s46, 524288
    s_mov_b32 s47, 0x20000
    s_mov_b32 m0, 152704
    s_nop 0
    buffer_load_dwordx4 v17, s[44:47], s69 offen lds
PB_LD_tr2:
    s_add_u32 m0, s54, 145536
    s_nop 0
    buffer_load_dwordx4 v17, s[44:47], s27 offen lds
PB_LD_noissue:
    s_add_u32 s26, s26, 1
    s_cmp_lt_u32 s26, 8
    s_cbranch_scc1 PB_LD_LOOP
    s_lshl_b32 s55, s49, 7
    v_lshlrev_b32 v20, 2, v8
    v_add_u32 v20, s55, v20
    v_add_u32 v20, 141440, v20
    v_lshlrev_b32 v9, 16, v9
    ds_write_b32 v20, v9
    s_waitcnt lgkmcnt(0)
    s_barrier
    s_barrier
    s_mov_b32 s60, s68
    s_mov_b32 s61, s70
    s_and_b32 s54, s2, 7
    s_lshr_b32 s55, s2, 3
    s_lshl_b32 s54, s54, 2
    s_lshr_b32 s56, s55, 3
    s_add_u32 s58, s54, s56
    s_and_b32 s59, s55, 7
    s_lshl_b32 s54, s59, 5
    s_add_u32 s54, s54, s58
    s_lshl_b32 s54, s54, 4
    s_add_u32 s70, s54, 14876672
K2_W2:
    s_sub_u32 s49, s48, 8
    s_mul_i32 s54, s49, 28672
    s_mul_i32 s65, s58, 229376
    s_add_u32 s65, s65, s54
    s_add_u32 s65, s65, 16777216
    s_add_u32 s66, s65, 114688
    s_mul_i32 s67, s59, 229376
    s_add_u32 s67, s67, s54
    s_add_u32 s67, s67, 10485760
    s_add_u32 s68, s67, 114688
    v_mov_b32 v84, 0
    v_mov_b32 v85, 0
    v_mov_b32 v86, 0
    v_mov_b32 v87, 0
    v_mov_b32 v88, 0
    v_mov_b32 v89, 0
    v_mov_b32 v90, 0
    v_mov_b32 v91, 0
    v_mov_b32 v92, 0
    v_mov_b32 v93, 0
    v_mov_b32 v94, 0
    v_mov_b32 v95, 0
    v_mov_b32 v96, 0
    v_mov_b32 v97, 0
    v_mov_b32 v98, 0
    v_mov_b32 v99, 0
    v_mov_b32 v100, 0
    v_mov_b32 v101, 0
    v_mov_b32 v102, 0
    v_mov_b32 v103, 0
    v_mov_b32 v104, 0
    v_mov_b32 v105, 0
    v_mov_b32 v106, 0
    v_mov_b32 v107, 0
    v_mov_b32 v108, 0
    v_mov_b32 v109, 0
    v_mov_b32 v110, 0
    v_mov_b32 v111, 0
    v_mov_b32 v112, 0
    v_mov_b32 v113, 0
    v_mov_b32 v114, 0
    v_mov_b32 v115, 0
    v_mov_b32 v116, 0
    v_mov_b32 v117, 0
    v_mov_b32 v118, 0
    v_mov_b32 v119, 0
    v_mov_b32 v120, 0
    v_mov_b32 v121, 0
    v_mov_b32 v122, 0
    v_mov_b32 v123, 0
    v_mov_b32 v124, 0
    v_mov_b32 v125, 0
    v_mov_b32 v126, 0
    v_mov_b32 v127, 0
    v_mov_b32 v128, 0
    v_mov_b32 v129, 0
    v_mov_b32 v130, 0
    v_mov_b32 v131, 0
    v_mov_b32 v132, 0
    v_mov_b32 v133, 0
    v_mov_b32 v134, 0
    v_mov_b32 v135, 0
    v_mov_b32 v136, 0
    v_mov_b32 v137, 0
    v_mov_b32 v138, 0
    v_mov_b32 v139, 0
    v_mov_b32 v140, 0
    v_mov_b32 v141, 0
    v_mov_b32 v142, 0
    v_mov_b32 v143, 0
    v_mov_b32 v144, 0
    v_mov_b32 v145, 0
    v_mov_b32 v146, 0
    v_mov_b32 v147, 0
    s_lshr_b32 s55, s49, 1
    s_lshl_b32 s56, s59, 1
    s_add_u32 s55, s55, s56
    s_lshl_b32 s56, s55, 6
    v_lshrrev_b32 v3, 5, v1
    v_lshlrev_b32 v3, 3, v3
    s_mov_b32 s28, s24
    s_mov_b32 s29, s25
    s_mov_b32 s30, 25165824
    s_mov_b32 s31, 0x20000
    s_mov_b32 s32, s18
    s_mov_b32 s33, s19
    s_mov_b32 s34, 1024
    s_mov_b32 s35, 0x20000
    buffer_load_dwordx2 v[148:149], v3, s[32:35], s56 offen offset:0
    buffer_load_dwordx2 v[150:151], v3, s[32:35], s56 offen offset:16
    buffer_load_dwordx2 v[152:153], v3, s[32:35], s56 offen offset:32
    buffer_load_dwordx2 v[154:155], v3, s[32:35], s56 offen offset:48
    s_and_b32 s56, s49, 1
    s_lshl_b32 s57, s58, 1
    s_add_u32 s56, s56, s57
    s_lshl_b32 s56, s56, 4
    s_add_u32 s56, s56, s55
    s_lshl_b32 s56, s56, 11
    s_add_u32 s69, s56, 8388608
    v_mov_b32 v166, 140288
    ds_read_b32 v166, v166
    s_lshr_b32 s54, s58, 1
    s_lshl_b32 s54, s54, 4
    s_lshl_b32 s55, s49, 2
    s_add_u32 s54, s54, s55
    s_lshl_b32 s54, s54, 4
    s_add_u32 s54, s54, 14811136
    s_lshl_b32 s55, s59, 5
    s_lshl_b32 s56, s49, 3
    s_add_u32 s55, s55, s56
    s_lshl_b32 s55, s55, 4
    s_add_u32 s55, s55, 14876672
    v_and_b32 v167, 7, v1
    v_lshlrev_b32 v167, 4, v167
    v_add_u32 v165, s54, v167
    v_add_u32 v167, s55, v167
    v_cmp_gt_u32 vcc, 4, v1
    s_mov_b32 s100, 0
    s_nop 0
    v_cndmask_b32 v167, v167, v165, vcc
    s_waitcnt lgkmcnt(0)
    v_readfirstlane_b32 s71, v166
    s_lshl_b32 s54, s58, 16
    s_lshl_b32 s64, s49, 11
    s_lshl_b32 s55, s59, 13
    s_add_u32 s57, s54, s64
    s_add_u32 s57, s57, s55
    s_add_u32 s63, s54, 4194304
    s_add_u32 s62, s54, 2097152
    s_mul_i32 s95, s59, 0
    s_add_u32 s95, s95, s64
    v_mov_b32 v6, 140316
    s_mov_b32 s100, 0
FZ_QI:
    ds_read_b32 v5, v6
    s_add_u32 s100, s100, 1
    s_waitcnt lgkmcnt(0)
    v_readfirstlane_b32 s54, v5
    s_cmp_ge_u32 s100, 1048576
    s_cbranch_scc1 FZ_QIx
    s_cmp_ge_u32 s54, 4
    s_cbranch_scc1 FZ_QIx
    s_sleep 1
    s_branch FZ_QI
FZ_QIx:
    s_add_u32 s55, s95, 8192
    s_and_b32 s55, s55, 0x7fff
    s_add_u32 s54, s55, s62
    s_add_u32 m0, s64, 8192
    s_nop 0
    buffer_load_dwordx4 v2, s[28:31], s54 offen sc1 lds
    s_add_u32 s54, s55, s63
    s_add_u32 m0, s64, 73728
    s_nop 0
    buffer_load_dwordx4 v2, s[28:31], s54 offen sc1 lds
    s_add_u32 s55, s95, 9216
    s_and_b32 s55, s55, 0x7fff
    s_add_u32 s54, s55, s62
    s_add_u32 m0, s64, 9216
    s_nop 0
    buffer_load_dwordx4 v2, s[28:31], s54 offen sc1 lds
    s_add_u32 s54, s55, s63
    s_add_u32 m0, s64, 74752
    s_nop 0
    buffer_load_dwordx4 v2, s[28:31], s54 offen sc1 lds
    s_add_u32 s55, s95, 8192
    s_and_b32 s55, s55, 0x7fff
    s_add_u32 s55, s55, 32768
    s_add_u32 s54, s55, s62
    s_add_u32 m0, s64, 40960
    s_nop 0
    buffer_load_dwordx4 v2, s[28:31], s54 offen sc1 lds
    s_add_u32 s54, s55, s63
    s_add_u32 m0, s64, 106496
    s_nop 0
    buffer_load_dwordx4 v2, s[28:31], s54 offen sc1 lds
    s_add_u32 s55, s95, 9216
    s_and_b32 s55, s55, 0x7fff
    s_add_u32 s55, s55, 32768
    s_add_u32 s54, s55, s62
    s_add_u32 m0, s64, 41984
    s_nop 0
    buffer_load_dwordx4 v2, s[28:31], s54 offen sc1 lds
    s_add_u32 s54, s55, s63
    s_add_u32 m0, s64, 107520
    s_nop 0
    buffer_load_dwordx4 v2, s[28:31], s54 offen sc1 lds
    s_add_u32 s55, s95, 16384
    s_and_b32 s55, s55, 0x7fff
    s_add_u32 s54, s55, s62
    s_add_u32 m0, s64, 16384
    s_nop 0
    buffer_load_dwordx4 v2, s[28:31], s54 offen sc1 lds
    s_add_u32 s54, s55, s63
    s_add_u32 m0, s64, 81920
    s_nop 0
    buffer_load_dwordx4 v2, s[28:31], s54 offen sc1 lds
    s_add_u32 s55, s95, 17408
    s_and_b32 s55, s55, 0x7fff
    s_add_u32 s54, s55, s62
    s_add_u32 m0, s64, 17408
    s_nop 0
    buffer_load_dwordx4 v2, s[28:31], s54 offen sc1 lds
    s_add_u32 s54, s55, s63
    s_add_u32 m0, s64, 82944
    s_nop 0
    buffer_load_dwordx4 v2, s[28:31], s54 offen sc1 lds
    s_add_u32 s55, s95, 16384
    s_and_b32 s55, s55, 0x7fff
    s_add_u32 s55, s55, 32768
    s_add_u32 s54, s55, s62
    s_add_u32 m0, s64, 49152
    s_nop 0
    buffer_load_dwordx4 v2, s[28:31], s54 offen sc1 lds
    s_add_u32 s54, s55, s63
    s_add_u32 m0, s64, 114688
    s_nop 0
    buffer_load_dwordx4 v2, s[28:31], s54 offen sc1 lds
    s_add_u32 s55, s95, 17408
    s_and_b32 s55, s55, 0x7fff
    s_add_u32 s55, s55, 32768
    s_add_u32 s54, s55, s62
    s_add_u32 m0, s64, 50176
    s_nop 0
    buffer_load_dwordx4 v2, s[28:31], s54 offen sc1 lds
    s_add_u32 s54, s55, s63
    s_add_u32 m0, s64, 115712
    s_nop 0
    buffer_load_dwordx4 v2, s[28:31], s54 offen sc1 lds
    s_add_u32 s55, s95, 24576
    s_and_b32 s55, s55, 0x7fff
    s_add_u32 s54, s55, s62
    s_add_u32 m0, s64, 24576
    s_nop 0
    buffer_load_dwordx4 v2, s[28:31], s54 offen sc1 lds
    s_add_u32 s54, s55, s63
    s_add_u32 m0, s64, 90112
    s_nop 0
    buffer_load_dwordx4 v2, s[28:31], s54 offen sc1 lds
    s_add_u32 s55, s95, 25600
    s_and_b32 s55, s55, 0x7fff
    s_add_u32 s54, s55, s62
    s_add_u32 m0, s64, 25600
    s_nop 0
    buffer_load_dwordx4 v2, s[28:31], s54 offen sc1 lds
    s_add_u32 s54, s55, s63
    s_add_u32 m0, s64, 91136
    s_nop 0
    buffer_load_dwordx4 v2, s[28:31], s54 offen sc1 lds
    s_add_u32 s55, s95, 24576
    s_and_b32 s55, s55, 0x7fff
    s_add_u32 s55, s55, 32768
    s_add_u32 s54, s55, s62
    s_add_u32 m0, s64, 57344
    s_nop 0
    buffer_load_dwordx4 v2, s[28:31], s54 offen sc1 lds
    s_add_u32 s54, s55, s63
    s_add_u32 m0, s64, 122880
    s_nop 0
    buffer_load_dwordx4 v2, s[28:31], s54 offen sc1 lds
    s_add_u32 s55, s95, 25600
    s_and_b32 s55, s55, 0x7fff
    s_add_u32 s55, s55, 32768
    s_add_u32 s54, s55, s62
    s_add_u32 m0, s64, 58368
    s_nop 0
    buffer_load_dwordx4 v2, s[28:31], s54 offen sc1 lds
    s_add_u32 s54, s55, s63
    s_add_u32 m0, s64, 123904
    s_nop 0
    buffer_load_dwordx4 v2, s[28:31], s54 offen sc1 lds
    s_barrier
    s_waitcnt vmcnt(24)
    ds_read_b64_tr_b16 v[28:29], v16
    ds_read_b64_tr_b16 v[30:31], v16 offset:512
    ds_read_b64_tr_b16 v[32:33], v16 offset:1024
    ds_read_b64_tr_b16 v[34:35], v16 offset:1536
    s_cmp_eq_u32 s49, 3
    s_cbranch_scc0 PB_ntr2
    ds_read_b64_tr_b16 v[36:37], v16 offset:2048
    ds_read_b64_tr_b16 v[38:39], v16 offset:2560
    s_waitcnt lgkmcnt(0)
    buffer_store_dwordx4 v[36:39], v2, s[28:31], s61 offen sc1
PB_ntr2:
    s_waitcnt lgkmcnt(0)
    buffer_store_dwordx4 v[28:31], v2, s[28:31], s60 offen sc1
    buffer_store_dwordx4 v[32:35], v2, s[28:31], s93 offen sc1
    s_waitcnt vmcnt(2)
    s_barrier
    v_mov_b32 v24, 140288
    v_mov_b32 v25, 1
    v_mov_b32 v26, 0
    s_mov_b64 exec, 1
    ds_read_b32 v27, v24
    s_waitcnt vmcnt(0)
    ds_add_rtn_u32 v25, v24, v25 offset:20
    s_waitcnt lgkmcnt(0)
    v_readfirstlane_b32 s54, v25
    s_nop 1
    s_cmp_eq_u32 s54, 3
    s_cbranch_scc0 FZ_PWx
    buffer_store_dword v27, v26, s[28:31], s70 offen sc1
FZ_PWx:
    s_mov_b64 exec, -1
K2_HP:
    buffer_load_dword v166, v167, s[28:31], 0 offen sc1
    s_add_u32 s100, s100, 1
    s_waitcnt vmcnt(0)
    v_cmp_ne_u32 vcc, s71, v166
    s_cmp_ge_u32 s100, 65536
    s_cbranch_scc1 K2_HPX
    s_cbranch_vccz K2_HPX
    s_sleep 2
    s_branch K2_HP
K2_HPX:
    buffer_load_dwordx4 v[4:7], v2, s[28:31], s65 offen offset:0 sc1
    buffer_load_dwordx4 v[8:11], v2, s[28:31], s67 offen offset:0 sc1
    buffer_load_dwordx4 v[12:15], v2, s[28:31], s66 offen offset:0 sc1
    buffer_load_dwordx4 v[16:19], v2, s[28:31], s68 offen offset:0 sc1
    buffer_load_dwordx4 v[20:23], v2, s[28:31], s65 offen offset:1024 sc1
    buffer_load_dwordx4 v[24:27], v2, s[28:31], s67 offen offset:1024 sc1
    buffer_load_dwordx4 v[28:31], v2, s[28:31], s66 offen offset:1024 sc1
    buffer_load_dwordx4 v[32:35], v2, s[28:31], s68 offen offset:1024 sc1
    buffer_load_dwordx4 v[36:39], v2, s[28:31], s65 offen offset:2048 sc1
    buffer_load_dwordx4 v[40:43], v2, s[28:31], s67 offen offset:2048 sc1
    buffer_load_dwordx4 v[44:47], v2, s[28:31], s66 offen offset:2048 sc1
    buffer_load_dwordx4 v[48:51], v2, s[28:31], s68 offen offset:2048 sc1
    buffer_load_dwordx4 v[52:55], v2, s[28:31], s65 offen offset:3072 sc1
    buffer_load_dwordx4 v[56:59], v2, s[28:31], s67 offen offset:3072 sc1
    buffer_load_dwordx4 v[60:63], v2, s[28:31], s66 offen offset:3072 sc1
    buffer_load_dwordx4 v[64:67], v2, s[28:31], s68 offen offset:3072 sc1
    s_add_u32 s65, s65, 4096
    s_add_u32 s66, s66, 4096
    s_add_u32 s67, s67, 4096
    s_add_u32 s68, s68, 4096
    buffer_load_dwordx4 v[68:71], v2, s[28:31], s65 offen offset:0 sc1
    buffer_load_dwordx4 v[72:75], v2, s[28:31], s67 offen offset:0 sc1
    buffer_load_dwordx4 v[76:79], v2, s[28:31], s66 offen offset:0 sc1
    buffer_load_dwordx4 v[80:83], v2, s[28:31], s68 offen offset:0 sc1
    s_waitcnt vmcnt(16)
    v_mfma_f32_32x32x16_bf16 v[84:99], v[8:11], v[4:7], v[84:99]
    v_mfma_f32_32x32x16_bf16 v[100:115], v[8:11], v[12:15], v[100:115]
    v_mfma_f32_32x32x16_bf16 v[116:131], v[16:19], v[4:7], v[116:131]
    v_mfma_f32_32x32x16_bf16 v[132:147], v[16:19], v[12:15], v[132:147]
    buffer_load_dwordx4 v[4:7], v2, s[28:31], s65 offen offset:1024 sc1
    buffer_load_dwordx4 v[8:11], v2, s[28:31], s67 offen offset:1024 sc1
    buffer_load_dwordx4 v[12:15], v2, s[28:31], s66 offen offset:1024 sc1
    buffer_load_dwordx4 v[16:19], v2, s[28:31], s68 offen offset:1024 sc1
    s_waitcnt vmcnt(16)
    v_mfma_f32_32x32x16_bf16 v[84:99], v[24:27], v[20:23], v[84:99]
    v_mfma_f32_32x32x16_bf16 v[100:115], v[24:27], v[28:31], v[100:115]
    v_mfma_f32_32x32x16_bf16 v[116:131], v[32:35], v[20:23], v[116:131]
    v_mfma_f32_32x32x16_bf16 v[132:147], v[32:35], v[28:31], v[132:147]
    buffer_load_dwordx4 v[20:23], v2, s[28:31], s65 offen offset:2048 sc1
    buffer_load_dwordx4 v[24:27], v2, s[28:31], s67 offen offset:2048 sc1
    buffer_load_dwordx4 v[28:31], v2, s[28:31], s66 offen offset:2048 sc1
    buffer_load_dwordx4 v[32:35], v2, s[28:31], s68 offen offset:2048 sc1
    s_waitcnt vmcnt(16)
    v_mfma_f32_32x32x16_bf16 v[84:99], v[40:43], v[36:39], v[84:99]
    v_mfma_f32_32x32x16_bf16 v[100:115], v[40:43], v[44:47], v[100:115]
    v_mfma_f32_32x32x16_bf16 v[116:131], v[48:51], v[36:39], v[116:131]
    v_mfma_f32_32x32x16_bf16 v[132:147], v[48:51], v[44:47], v[132:147]
    buffer_load_dwordx4 v[36:39], v2, s[28:31], s65 offen offset:3072 sc1
    buffer_load_dwordx4 v[40:43], v2, s[28:31], s67 offen offset:3072 sc1
    buffer_load_dwordx4 v[44:47], v2, s[28:31], s66 offen offset:3072 sc1
    buffer_load_dwordx4 v[48:51], v2, s[28:31], s68 offen offset:3072 sc1
    s_waitcnt vmcnt(16)
    v_mfma_f32_32x32x16_bf16 v[84:99], v[56:59], v[52:55], v[84:99]
    v_mfma_f32_32x32x16_bf16 v[100:115], v[56:59], v[60:63], v[100:115]
    v_mfma_f32_32x32x16_bf16 v[116:131], v[64:67], v[52:55], v[116:131]
    v_mfma_f32_32x32x16_bf16 v[132:147], v[64:67], v[60:63], v[132:147]
    s_add_u32 s65, s65, 4096
    s_add_u32 s66, s66, 4096
    s_add_u32 s67, s67, 4096
    s_add_u32 s68, s68, 4096
    buffer_load_dwordx4 v[52:55], v2, s[28:31], s65 offen offset:0 sc1
    buffer_load_dwordx4 v[56:59], v2, s[28:31], s67 offen offset:0 sc1
    buffer_load_dwordx4 v[60:63], v2, s[28:31], s66 offen offset:0 sc1
    buffer_load_dwordx4 v[64:67], v2, s[28:31], s68 offen offset:0 sc1
    s_waitcnt vmcnt(16)
    v_mfma_f32_32x32x16_bf16 v[84:99], v[72:75], v[68:71], v[84:99]
    v_mfma_f32_32x32x16_bf16 v[100:115], v[72:75], v[76:79], v[100:115]
    v_mfma_f32_32x32x16_bf16 v[116:131], v[80:83], v[68:71], v[116:131]
    v_mfma_f32_32x32x16_bf16 v[132:147], v[80:83], v[76:79], v[132:147]
    buffer_load_dwordx4 v[68:71], v2, s[28:31], s65 offen offset:1024 sc1
    buffer_load_dwordx4 v[72:75], v2, s[28:31], s67 offen offset:1024 sc1
    buffer_load_dwordx4 v[76:79], v2, s[28:31], s66 offen offset:1024 sc1
    buffer_load_dwordx4 v[80:83], v2, s[28:31], s68 offen offset:1024 sc1
    s_waitcnt vmcnt(16)
    v_mfma_f32_32x32x16_bf16 v[84:99], v[8:11], v[4:7], v[84:99]
    v_mfma_f32_32x32x16_bf16 v[100:115], v[8:11], v[12:15], v[100:115]
    v_mfma_f32_32x32x16_bf16 v[116:131], v[16:19], v[4:7], v[116:131]
    v_mfma_f32_32x32x16_bf16 v[132:147], v[16:19], v[12:15], v[132:147]
    buffer_load_dwordx4 v[4:7], v2, s[28:31], s65 offen offset:2048 sc1
    buffer_load_dwordx4 v[8:11], v2, s[28:31], s67 offen offset:2048 sc1
    buffer_load_dwordx4 v[12:15], v2, s[28:31], s66 offen offset:2048 sc1
    buffer_load_dwordx4 v[16:19], v2, s[28:31], s68 offen offset:2048 sc1
    s_waitcnt vmcnt(16)
    v_mfma_f32_32x32x16_bf16 v[84:99], v[24:27], v[20:23], v[84:99]
    v_mfma_f32_32x32x16_bf16 v[100:115], v[24:27], v[28:31], v[100:115]
    v_mfma_f32_32x32x16_bf16 v[116:131], v[32:35], v[20:23], v[116:131]
    v_mfma_f32_32x32x16_bf16 v[132:147], v[32:35], v[28:31], v[132:147]
    buffer_load_dwordx4 v[20:23], v2, s[28:31], s65 offen offset:3072 sc1
    buffer_load_dwordx4 v[24:27], v2, s[28:31], s67 offen offset:3072 sc1
    buffer_load_dwordx4 v[28:31], v2, s[28:31], s66 offen offset:3072 sc1
    buffer_load_dwordx4 v[32:35], v2, s[28:31], s68 offen offset:3072 sc1
    s_waitcnt vmcnt(16)
    v_mfma_f32_32x32x16_bf16 v[84:99], v[40:43], v[36:39], v[84:99]
    v_mfma_f32_32x32x16_bf16 v[100:115], v[40:43], v[44:47], v[100:115]
    v_mfma_f32_32x32x16_bf16 v[116:131], v[48:51], v[36:39], v[116:131]
    v_mfma_f32_32x32x16_bf16 v[132:147], v[48:51], v[44:47], v[132:147]
    s_add_u32 s65, s65, 4096
    s_add_u32 s66, s66, 4096
    s_add_u32 s67, s67, 4096
    s_add_u32 s68, s68, 4096
    buffer_load_dwordx4 v[36:39], v2, s[28:31], s65 offen offset:0 sc1
    buffer_load_dwordx4 v[40:43], v2, s[28:31], s67 offen offset:0 sc1
    buffer_load_dwordx4 v[44:47], v2, s[28:31], s66 offen offset:0 sc1
    buffer_load_dwordx4 v[48:51], v2, s[28:31], s68 offen offset:0 sc1
    s_waitcnt vmcnt(16)
    v_mfma_f32_32x32x16_bf16 v[84:99], v[56:59], v[52:55], v[84:99]
    v_mfma_f32_32x32x16_bf16 v[100:115], v[56:59], v[60:63], v[100:115]
    v_mfma_f32_32x32x16_bf16 v[116:131], v[64:67], v[52:55], v[116:131]
    v_mfma_f32_32x32x16_bf16 v[132:147], v[64:67], v[60:63], v[132:147]
    buffer_load_dwordx4 v[52:55], v2, s[28:31], s65 offen offset:1024 sc1
    buffer_load_dwordx4 v[56:59], v2, s[28:31], s67 offen offset:1024 sc1
    buffer_load_dwordx4 v[60:63], v2, s[28:31], s66 offen offset:1024 sc1
    buffer_load_dwordx4 v[64:67], v2, s[28:31], s68 offen offset:1024 sc1
    s_waitcnt vmcnt(16)
    v_mfma_f32_32x32x16_bf16 v[84:99], v[72:75], v[68:71], v[84:99]
    v_mfma_f32_32x32x16_bf16 v[100:115], v[72:75], v[76:79], v[100:115]
    v_mfma_f32_32x32x16_bf16 v[116:131], v[80:83], v[68:71], v[116:131]
    v_mfma_f32_32x32x16_bf16 v[132:147], v[80:83], v[76:79], v[132:147]
    buffer_load_dwordx4 v[68:71], v2, s[28:31], s65 offen offset:2048 sc1
    buffer_load_dwordx4 v[72:75], v2, s[28:31], s67 offen offset:2048 sc1
    buffer_load_dwordx4 v[76:79], v2, s[28:31], s66 offen offset:2048 sc1
    buffer_load_dwordx4 v[80:83], v2, s[28:31], s68 offen offset:2048 sc1
    s_waitcnt vmcnt(16)
    v_mfma_f32_32x32x16_bf16 v[84:99], v[8:11], v[4:7], v[84:99]
    v_mfma_f32_32x32x16_bf16 v[100:115], v[8:11], v[12:15], v[100:115]
    v_mfma_f32_32x32x16_bf16 v[116:131], v[16:19], v[4:7], v[116:131]
    v_mfma_f32_32x32x16_bf16 v[132:147], v[16:19], v[12:15], v[132:147]
    buffer_load_dwordx4 v[4:7], v2, s[28:31], s65 offen offset:3072 sc1
    buffer_load_dwordx4 v[8:11], v2, s[28:31], s67 offen offset:3072 sc1
    buffer_load_dwordx4 v[12:15], v2, s[28:31], s66 offen offset:3072 sc1
    buffer_load_dwordx4 v[16:19], v2, s[28:31], s68 offen offset:3072 sc1
    s_waitcnt vmcnt(16)
    v_mfma_f32_32x32x16_bf16 v[84:99], v[24:27], v[20:23], v[84:99]
    v_mfma_f32_32x32x16_bf16 v[100:115], v[24:27], v[28:31], v[100:115]
    v_mfma_f32_32x32x16_bf16 v[116:131], v[32:35], v[20:23], v[116:131]
    v_mfma_f32_32x32x16_bf16 v[132:147], v[32:35], v[28:31], v[132:147]
    s_add_u32 s65, s65, 4096
    s_add_u32 s66, s66, 4096
    s_add_u32 s67, s67, 4096
    s_add_u32 s68, s68, 4096
    buffer_load_dwordx4 v[20:23], v2, s[28:31], s65 offen offset:0 sc1
    buffer_load_dwordx4 v[24:27], v2, s[28:31], s67 offen offset:0 sc1
    buffer_load_dwordx4 v[28:31], v2, s[28:31], s66 offen offset:0 sc1
    buffer_load_dwordx4 v[32:35], v2, s[28:31], s68 offen offset:0 sc1
    s_waitcnt vmcnt(16)
    v_mfma_f32_32x32x16_bf16 v[84:99], v[40:43], v[36:39], v[84:99]
    v_mfma_f32_32x32x16_bf16 v[100:115], v[40:43], v[44:47], v[100:115]
    v_mfma_f32_32x32x16_bf16 v[116:131], v[48:51], v[36:39], v[116:131]
    v_mfma_f32_32x32x16_bf16 v[132:147], v[48:51], v[44:47], v[132:147]
    buffer_load_dwordx4 v[36:39], v2, s[28:31], s65 offen offset:1024 sc1
    buffer_load_dwordx4 v[40:43], v2, s[28:31], s67 offen offset:1024 sc1
    buffer_load_dwordx4 v[44:47], v2, s[28:31], s66 offen offset:1024 sc1
    buffer_load_dwordx4 v[48:51], v2, s[28:31], s68 offen offset:1024 sc1
    s_waitcnt vmcnt(16)
    v_mfma_f32_32x32x16_bf16 v[84:99], v[56:59], v[52:55], v[84:99]
    v_mfma_f32_32x32x16_bf16 v[100:115], v[56:59], v[60:63], v[100:115]
    v_mfma_f32_32x32x16_bf16 v[116:131], v[64:67], v[52:55], v[116:131]
    v_mfma_f32_32x32x16_bf16 v[132:147], v[64:67], v[60:63], v[132:147]
    buffer_load_dwordx4 v[52:55], v2, s[28:31], s65 offen offset:2048 sc1
    buffer_load_dwordx4 v[56:59], v2, s[28:31], s67 offen offset:2048 sc1
    buffer_load_dwordx4 v[60:63], v2, s[28:31], s66 offen offset:2048 sc1
    buffer_load_dwordx4 v[64:67], v2, s[28:31], s68 offen offset:2048 sc1
    s_waitcnt vmcnt(16)
    v_mfma_f32_32x32x16_bf16 v[84:99], v[72:75], v[68:71], v[84:99]
    v_mfma_f32_32x32x16_bf16 v[100:115], v[72:75], v[76:79], v[100:115]
    v_mfma_f32_32x32x16_bf16 v[116:131], v[80:83], v[68:71], v[116:131]
    v_mfma_f32_32x32x16_bf16 v[132:147], v[80:83], v[76:79], v[132:147]
    buffer_load_dwordx4 v[68:71], v2, s[28:31], s65 offen offset:3072 sc1
    buffer_load_dwordx4 v[72:75], v2, s[28:31], s67 offen offset:3072 sc1
    buffer_load_dwordx4 v[76:79], v2, s[28:31], s66 offen offset:3072 sc1
    buffer_load_dwordx4 v[80:83], v2, s[28:31], s68 offen offset:3072 sc1
    s_waitcnt vmcnt(16)
    v_mfma_f32_32x32x16_bf16 v[84:99], v[8:11], v[4:7], v[84:99]
    v_mfma_f32_32x32x16_bf16 v[100:115], v[8:11], v[12:15], v[100:115]
    v_mfma_f32_32x32x16_bf16 v[116:131], v[16:19], v[4:7], v[116:131]
    v_mfma_f32_32x32x16_bf16 v[132:147], v[16:19], v[12:15], v[132:147]
    s_add_u32 s65, s65, 4096
    s_add_u32 s66, s66, 4096
    s_add_u32 s67, s67, 4096
    s_add_u32 s68, s68, 4096
    buffer_load_dwordx4 v[4:7], v2, s[28:31], s65 offen offset:0 sc1
    buffer_load_dwordx4 v[8:11], v2, s[28:31], s67 offen offset:0 sc1
    buffer_load_dwordx4 v[12:15], v2, s[28:31], s66 offen offset:0 sc1
    buffer_load_dwordx4 v[16:19], v2, s[28:31], s68 offen offset:0 sc1
    s_waitcnt vmcnt(16)
    v_mfma_f32_32x32x16_bf16 v[84:99], v[24:27], v[20:23], v[84:99]
    v_mfma_f32_32x32x16_bf16 v[100:115], v[24:27], v[28:31], v[100:115]
    v_mfma_f32_32x32x16_bf16 v[116:131], v[32:35], v[20:23], v[116:131]
    v_mfma_f32_32x32x16_bf16 v[132:147], v[32:35], v[28:31], v[132:147]
    buffer_load_dwordx4 v[20:23], v2, s[28:31], s65 offen offset:1024 sc1
    buffer_load_dwordx4 v[24:27], v2, s[28:31], s67 offen offset:1024 sc1
    buffer_load_dwordx4 v[28:31], v2, s[28:31], s66 offen offset:1024 sc1
    buffer_load_dwordx4 v[32:35], v2, s[28:31], s68 offen offset:1024 sc1
    s_waitcnt vmcnt(16)
    v_mfma_f32_32x32x16_bf16 v[84:99], v[40:43], v[36:39], v[84:99]
    v_mfma_f32_32x32x16_bf16 v[100:115], v[40:43], v[44:47], v[100:115]
    v_mfma_f32_32x32x16_bf16 v[116:131], v[48:51], v[36:39], v[116:131]
    v_mfma_f32_32x32x16_bf16 v[132:147], v[48:51], v[44:47], v[132:147]
    buffer_load_dwordx4 v[36:39], v2, s[28:31], s65 offen offset:2048 sc1
    buffer_load_dwordx4 v[40:43], v2, s[28:31], s67 offen offset:2048 sc1
    buffer_load_dwordx4 v[44:47], v2, s[28:31], s66 offen offset:2048 sc1
    buffer_load_dwordx4 v[48:51], v2, s[28:31], s68 offen offset:2048 sc1
    s_waitcnt vmcnt(16)
    v_mfma_f32_32x32x16_bf16 v[84:99], v[56:59], v[52:55], v[84:99]
    v_mfma_f32_32x32x16_bf16 v[100:115], v[56:59], v[60:63], v[100:115]
    v_mfma_f32_32x32x16_bf16 v[116:131], v[64:67], v[52:55], v[116:131]
    v_mfma_f32_32x32x16_bf16 v[132:147], v[64:67], v[60:63], v[132:147]
    buffer_load_dwordx4 v[52:55], v2, s[28:31], s65 offen offset:3072 sc1
    buffer_load_dwordx4 v[56:59], v2, s[28:31], s67 offen offset:3072 sc1
    buffer_load_dwordx4 v[60:63], v2, s[28:31], s66 offen offset:3072 sc1
    buffer_load_dwordx4 v[64:67], v2, s[28:31], s68 offen offset:3072 sc1
    s_waitcnt vmcnt(16)
    v_mfma_f32_32x32x16_bf16 v[84:99], v[72:75], v[68:71], v[84:99]
    v_mfma_f32_32x32x16_bf16 v[100:115], v[72:75], v[76:79], v[100:115]
    v_mfma_f32_32x32x16_bf16 v[116:131], v[80:83], v[68:71], v[116:131]
    v_mfma_f32_32x32x16_bf16 v[132:147], v[80:83], v[76:79], v[132:147]
    s_add_u32 s65, s65, 4096
    s_add_u32 s66, s66, 4096
    s_add_u32 s67, s67, 4096
    s_add_u32 s68, s68, 4096
    buffer_load_dwordx4 v[68:71], v2, s[28:31], s65 offen offset:0 sc1
    buffer_load_dwordx4 v[72:75], v2, s[28:31], s67 offen offset:0 sc1
    buffer_load_dwordx4 v[76:79], v2, s[28:31], s66 offen offset:0 sc1
    buffer_load_dwordx4 v[80:83], v2, s[28:31], s68 offen offset:0 sc1
    s_waitcnt vmcnt(16)
    v_mfma_f32_32x32x16_bf16 v[84:99], v[8:11], v[4:7], v[84:99]
    v_mfma_f32_32x32x16_bf16 v[100:115], v[8:11], v[12:15], v[100:115]
    v_mfma_f32_32x32x16_bf16 v[116:131], v[16:19], v[4:7], v[116:131]
    v_mfma_f32_32x32x16_bf16 v[132:147], v[16:19], v[12:15], v[132:147]
    buffer_load_dwordx4 v[4:7], v2, s[28:31], s65 offen offset:1024 sc1
    buffer_load_dwordx4 v[8:11], v2, s[28:31], s67 offen offset:1024 sc1
    buffer_load_dwordx4 v[12:15], v2, s[28:31], s66 offen offset:1024 sc1
    buffer_load_dwordx4 v[16:19], v2, s[28:31], s68 offen offset:1024 sc1
    s_waitcnt vmcnt(16)
    v_mfma_f32_32x32x16_bf16 v[84:99], v[24:27], v[20:23], v[84:99]
    v_mfma_f32_32x32x16_bf16 v[100:115], v[24:27], v[28:31], v[100:115]
    v_mfma_f32_32x32x16_bf16 v[116:131], v[32:35], v[20:23], v[116:131]
    v_mfma_f32_32x32x16_bf16 v[132:147], v[32:35], v[28:31], v[132:147]
    buffer_load_dwordx4 v[20:23], v2, s[28:31], s65 offen offset:2048 sc1
    buffer_load_dwordx4 v[24:27], v2, s[28:31], s67 offen offset:2048 sc1
    buffer_load_dwordx4 v[28:31], v2, s[28:31], s66 offen offset:2048 sc1
    buffer_load_dwordx4 v[32:35], v2, s[28:31], s68 offen offset:2048 sc1
    s_waitcnt vmcnt(16)
    v_mfma_f32_32x32x16_bf16 v[84:99], v[40:43], v[36:39], v[84:99]
    v_mfma_f32_32x32x16_bf16 v[100:115], v[40:43], v[44:47], v[100:115]
    v_mfma_f32_32x32x16_bf16 v[116:131], v[48:51], v[36:39], v[116:131]
    v_mfma_f32_32x32x16_bf16 v[132:147], v[48:51], v[44:47], v[132:147]
    buffer_load_dwordx4 v[36:39], v2, s[28:31], s65 offen offset:3072 sc1
    buffer_load_dwordx4 v[40:43], v2, s[28:31], s67 offen offset:3072 sc1
    buffer_load_dwordx4 v[44:47], v2, s[28:31], s66 offen offset:3072 sc1
    buffer_load_dwordx4 v[48:51], v2, s[28:31], s68 offen offset:3072 sc1
    s_waitcnt vmcnt(16)
    v_mfma_f32_32x32x16_bf16 v[84:99], v[56:59], v[52:55], v[84:99]
    v_mfma_f32_32x32x16_bf16 v[100:115], v[56:59], v[60:63], v[100:115]
    v_mfma_f32_32x32x16_bf16 v[116:131], v[64:67], v[52:55], v[116:131]
    v_mfma_f32_32x32x16_bf16 v[132:147], v[64:67], v[60:63], v[132:147]
    s_waitcnt vmcnt(12)
    v_mfma_f32_32x32x16_bf16 v[84:99], v[72:75], v[68:71], v[84:99]
    v_mfma_f32_32x32x16_bf16 v[100:115], v[72:75], v[76:79], v[100:115]
    v_mfma_f32_32x32x16_bf16 v[116:131], v[80:83], v[68:71], v[116:131]
    v_mfma_f32_32x32x16_bf16 v[132:147], v[80:83], v[76:79], v[132:147]
    s_waitcnt vmcnt(8)
    v_mfma_f32_32x32x16_bf16 v[84:99], v[8:11], v[4:7], v[84:99]
    v_mfma_f32_32x32x16_bf16 v[100:115], v[8:11], v[12:15], v[100:115]
    v_mfma_f32_32x32x16_bf16 v[116:131], v[16:19], v[4:7], v[116:131]
    v_mfma_f32_32x32x16_bf16 v[132:147], v[16:19], v[12:15], v[132:147]
    s_waitcnt vmcnt(4)
    v_mfma_f32_32x32x16_bf16 v[84:99], v[24:27], v[20:23], v[84:99]
    v_mfma_f32_32x32x16_bf16 v[100:115], v[24:27], v[28:31], v[100:115]
    v_mfma_f32_32x32x16_bf16 v[116:131], v[32:35], v[20:23], v[116:131]
    v_mfma_f32_32x32x16_bf16 v[132:147], v[32:35], v[28:31], v[132:147]
    s_waitcnt vmcnt(0)
    v_mfma_f32_32x32x16_bf16 v[84:99], v[40:43], v[36:39], v[84:99]
    v_mfma_f32_32x32x16_bf16 v[100:115], v[40:43], v[44:47], v[100:115]
    v_mfma_f32_32x32x16_bf16 v[116:131], v[48:51], v[36:39], v[116:131]
    v_mfma_f32_32x32x16_bf16 v[132:147], v[48:51], v[44:47], v[132:147]
    s_mov_b32 s36, s4
    s_mov_b32 s37, s5
    s_mov_b32 s38, 2097152
    s_mov_b32 s39, 0x20000
    s_mov_b32 s40, s20
    s_mov_b32 s41, s21
    s_mov_b32 s42, 2097152
    s_mov_b32 s43, 0x20000
    s_mov_b32 s44, s22
    s_mov_b32 s45, s23
    s_mov_b32 s46, 256
    s_mov_b32 s47, 0x20000
    s_and_b32 s54, s49, 1
    s_lshl_b32 s55, s58, 1
    s_add_u32 s54, s54, s55
    s_lshr_b32 s55, s49, 1
    s_lshl_b32 s56, s59, 1
    s_add_u32 s55, s55, s56
    s_lshl_b32 s94, s54, 15
    s_lshl_b32 s55, s55, 6
    s_add_u32 s94, s94, s55
    v_and_b32 v164, 31, v1
    v_lshlrev_b32 v164, 10, v164
    v_lshrrev_b32 v166, 5, v1
    v_lshlrev_b32 v166, 3, v166
    v_add_u32 v164, v164, v166
    buffer_load_dwordx2 v[156:157], v164, s[36:39], s94 offen offset:0
    buffer_load_dwordx2 v[158:159], v164, s[36:39], s94 offen offset:16
    buffer_load_dwordx2 v[160:161], v164, s[36:39], s94 offen offset:32
    buffer_load_dwordx2 v[162:163], v164, s[36:39], s94 offen offset:48
    v_add_u32 v164, v164, v166
    s_lshl_b32 s54, s49, 13
    s_lshl_b32 s95, s58, 16
    s_add_u32 s95, s95, s54
    s_add_u32 s95, s95, 6291456
    s_add_u32 s3, s95, 32768
    s_lshl_b32 s101, s59, 16
    s_add_u32 s101, s101, s54
    s_add_u32 s101, s101, 12582912
    s_lshr_b32 s93, s58, 2
    s_lshl_b32 s93, s93, 5
    s_lshl_b32 s54, s49, 3
    s_add_u32 s93, s93, s54
    s_mul_i32 s93, s93, 16
    s_add_u32 s93, s93, 14680064
    s_add_u32 s54, s101, 32768
    buffer_load_dwordx4 v[4:7], v2, s[28:31], s101 offen offset:0 sc1
    buffer_load_dwordx4 v[8:11], v2, s[28:31], s54 offen offset:0 sc1
    s_add_u32 s54, s101, 32768
    buffer_load_dwordx4 v[12:15], v2, s[28:31], s101 offen offset:1024 sc1
    buffer_load_dwordx4 v[16:19], v2, s[28:31], s54 offen offset:1024 sc1
    s_add_u32 s54, s101, 32768
    buffer_load_dwordx4 v[20:23], v2, s[28:31], s101 offen offset:2048 sc1
    buffer_load_dwordx4 v[24:27], v2, s[28:31], s54 offen offset:2048 sc1
    s_add_u32 s54, s101, 32768
    buffer_load_dwordx4 v[28:31], v2, s[28:31], s101 offen offset:3072 sc1
    buffer_load_dwordx4 v[32:35], v2, s[28:31], s54 offen offset:3072 sc1
    s_add_u32 s101, s101, 4096
    s_add_u32 s54, s101, 32768
    buffer_load_dwordx4 v[36:39], v2, s[28:31], s101 offen offset:0 sc1
    buffer_load_dwordx4 v[40:43], v2, s[28:31], s54 offen offset:0 sc1
    s_add_u32 s54, s101, 32768
    buffer_load_dwordx4 v[44:47], v2, s[28:31], s101 offen offset:1024 sc1
    buffer_load_dwordx4 v[48:51], v2, s[28:31], s54 offen offset:1024 sc1
    s_add_u32 s54, s101, 32768
    buffer_load_dwordx4 v[52:55], v2, s[28:31], s101 offen offset:2048 sc1
    buffer_load_dwordx4 v[56:59], v2, s[28:31], s54 offen offset:2048 sc1
    s_add_u32 s54, s101, 32768
    buffer_load_dwordx4 v[60:63], v2, s[28:31], s101 offen offset:3072 sc1
    buffer_load_dwordx4 v[64:67], v2, s[28:31], s54 offen offset:3072 sc1
    s_nop 7
    s_nop 7
    s_barrier
    s_barrier
    v_mov_b32 v166, 140296
    v_mov_b32 v167, 1
    v_add_u32 v3, 20480, v2
    s_cmp_eq_u32 s49, 0
    s_cbranch_scc1 K2_R0
    s_cmp_eq_u32 s49, 1
    s_cbranch_scc1 K2_R1
    s_cmp_eq_u32 s49, 2
    s_cbranch_scc1 K2_R2
    ds_write_b128 v3, v[84:87] offset:8192
    ds_write_b128 v3, v[88:91] offset:9216
    ds_write_b128 v3, v[92:95] offset:10240
    ds_write_b128 v3, v[96:99] offset:11264
    ds_write_b128 v3, v[100:103] offset:16384
    ds_write_b128 v3, v[104:107] offset:17408
    ds_write_b128 v3, v[108:111] offset:18432
    ds_write_b128 v3, v[112:115] offset:19456
    ds_write_b128 v3, v[116:119] offset:24576
    ds_write_b128 v3, v[120:123] offset:25600
    ds_write_b128 v3, v[124:127] offset:26624
    ds_write_b128 v3, v[128:131] offset:27648
    v_lshlrev_b32 v68, 16, v148
    v_and_b32 v69, 0xffff0000, v148
    v_lshlrev_b32 v70, 16, v149
    v_and_b32 v71, 0xffff0000, v149
    v_lshlrev_b32 v72, 16, v150
    v_and_b32 v73, 0xffff0000, v150
    v_lshlrev_b32 v74, 16, v151
    v_and_b32 v75, 0xffff0000, v151
    v_lshlrev_b32 v76, 16, v152
    v_and_b32 v77, 0xffff0000, v152
    v_lshlrev_b32 v78, 16, v153
    v_and_b32 v79, 0xffff0000, v153
    v_lshlrev_b32 v80, 16, v154
    v_and_b32 v81, 0xffff0000, v154
    v_lshlrev_b32 v82, 16, v155
    v_and_b32 v83, 0xffff0000, v155
    v_add_f32 v132, v132, v68
    v_add_f32 v133, v133, v69
    v_add_f32 v134, v134, v70
    v_add_f32 v135, v135, v71
    v_add_f32 v136, v136, v72
    v_add_f32 v137, v137, v73
    v_add_f32 v138, v138, v74
    v_add_f32 v139, v139, v75
    v_add_f32 v140, v140, v76
    v_add_f32 v141, v141, v77
    v_add_f32 v142, v142, v78
    v_add_f32 v143, v143, v79
    v_add_f32 v144, v144, v80
    v_add_f32 v145, v145, v81
    v_add_f32 v146, v146, v82
    v_add_f32 v147, v147, v83
    s_waitcnt lgkmcnt(0)
    s_mov_b64 exec, 1
    ds_add_u32 v166, v167
    s_mov_b64 exec, -1
    s_mov_b32 s100, 0
K2_WB1:
    ds_read_b32 v165, v166
    s_add_u32 s100, s100, 1
    s_waitcnt lgkmcnt(0)
    v_readfirstlane_b32 s54, v165
    s_cmp_ge_u32 s100, 65536
    s_cbranch_scc1 K2_WB1x
    s_cmp_ge_u32 s54, 4
    s_cbranch_scc1 K2_WB1x
    s_sleep 2
    s_branch K2_WB1
K2_WB1x:
    ds_read_b128 v[84:87], v3 offset:36864
    ds_read_b128 v[88:91], v3 offset:37888
    ds_read_b128 v[92:95], v3 offset:38912
    ds_read_b128 v[96:99], v3 offset:39936
    ds_read_b128 v[100:103], v3 offset:40960
    ds_read_b128 v[104:107], v3 offset:41984
    ds_read_b128 v[108:111], v3 offset:43008
    ds_read_b128 v[112:115], v3 offset:44032
    ds_read_b128 v[116:119], v3 offset:45056
    ds_read_b128 v[120:123], v3 offset:46080
    ds_read_b128 v[124:127], v3 offset:47104
    ds_read_b128 v[128:131], v3 offset:48128
    s_waitcnt lgkmcnt(8)
    v_add_f32 v132, v132, v84
    v_add_f32 v133, v133, v85
    v_add_f32 v134, v134, v86
    v_add_f32 v135, v135, v87
    v_add_f32 v136, v136, v88
    v_add_f32 v137, v137, v89
    v_add_f32 v138, v138, v90
    v_add_f32 v139, v139, v91
    v_add_f32 v140, v140, v92
    v_add_f32 v141, v141, v93
    v_add_f32 v142, v142, v94
    v_add_f32 v143, v143, v95
    v_add_f32 v144, v144, v96
    v_add_f32 v145, v145, v97
    v_add_f32 v146, v146, v98
    v_add_f32 v147, v147, v99
    s_waitcnt lgkmcnt(4)
    v_add_f32 v132, v132, v100
    v_add_f32 v133, v133, v101
    v_add_f32 v134, v134, v102
    v_add_f32 v135, v135, v103
    v_add_f32 v136, v136, v104
    v_add_f32 v137, v137, v105
    v_add_f32 v138, v138, v106
    v_add_f32 v139, v139, v107
    v_add_f32 v140, v140, v108
    v_add_f32 v141, v141, v109
    v_add_f32 v142, v142, v110
    v_add_f32 v143, v143, v111
    v_add_f32 v144, v144, v112
    v_add_f32 v145, v145, v113
    v_add_f32 v146, v146, v114
    v_add_f32 v147, v147, v115
    s_waitcnt lgkmcnt(0)
    v_add_f32 v132, v132, v116
    v_add_f32 v133, v133, v117
    v_add_f32 v134, v134, v118
    v_add_f32 v135, v135, v119
    v_add_f32 v136, v136, v120
    v_add_f32 v137, v137, v121
    v_add_f32 v138, v138, v122
    v_add_f32 v139, v139, v123
    v_add_f32 v140, v140, v124
    v_add_f32 v141, v141, v125
    v_add_f32 v142, v142, v126
    v_add_f32 v143, v143, v127
    v_add_f32 v144, v144, v128
    v_add_f32 v145, v145, v129
    v_add_f32 v146, v146, v130
    v_add_f32 v147, v147, v131
    v_mul_f32 v68, 0xbfb8aa3b, v132
    v_mul_f32 v69, 0xbfb8aa3b, v133
    v_mul_f32 v70, 0xbfb8aa3b, v134
    v_mul_f32 v71, 0xbfb8aa3b, v135
    v_mul_f32 v72, 0xbfb8aa3b, v136
    v_mul_f32 v73, 0xbfb8aa3b, v137
    v_mul_f32 v74, 0xbfb8aa3b, v138
    v_mul_f32 v75, 0xbfb8aa3b, v139
    v_mul_f32 v76, 0xbfb8aa3b, v140
    v_mul_f32 v77, 0xbfb8aa3b, v141
    v_mul_f32 v78, 0xbfb8aa3b, v142
    v_mul_f32 v79, 0xbfb8aa3b, v143
    v_mul_f32 v80, 0xbfb8aa3b, v144
    v_mul_f32 v81, 0xbfb8aa3b, v145
    v_mul_f32 v82, 0xbfb8aa3b, v146
    v_mul_f32 v83, 0xbfb8aa3b, v147
    v_exp_f32 v68, v68
    v_exp_f32 v69, v69
    v_exp_f32 v70, v70
    v_exp_f32 v71, v71
    v_exp_f32 v72, v72
    v_exp_f32 v73, v73
    v_exp_f32 v74, v74
    v_exp_f32 v75, v75
    v_exp_f32 v76, v76
    v_exp_f32 v77, v77
    v_exp_f32 v78, v78
    v_exp_f32 v79, v79
    v_exp_f32 v80, v80
    v_exp_f32 v81, v81
    v_exp_f32 v82, v82
    v_exp_f32 v83, v83
    v_add_f32 v68, 1.0, v68
    v_add_f32 v69, 1.0, v69
    v_add_f32 v70, 1.0, v70
    v_add_f32 v71, 1.0, v71
    v_add_f32 v72, 1.0, v72
    v_add_f32 v73, 1.0, v73
    v_add_f32 v74, 1.0, v74
    v_add_f32 v75, 1.0, v75
    v_add_f32 v76, 1.0, v76
    v_add_f32 v77, 1.0, v77
    v_add_f32 v78, 1.0, v78
    v_add_f32 v79, 1.0, v79
    v_add_f32 v80, 1.0, v80
    v_add_f32 v81, 1.0, v81
    v_add_f32 v82, 1.0, v82
    v_add_f32 v83, 1.0, v83
    v_rcp_f32 v68, v68
    v_rcp_f32 v69, v69
    v_rcp_f32 v70, v70
    v_rcp_f32 v71, v71
    v_rcp_f32 v72, v72
    v_rcp_f32 v73, v73
    v_rcp_f32 v74, v74
    v_rcp_f32 v75, v75
    v_rcp_f32 v76, v76
    v_rcp_f32 v77, v77
    v_rcp_f32 v78, v78
    v_rcp_f32 v79, v79
    v_rcp_f32 v80, v80
    v_rcp_f32 v81, v81
    v_rcp_f32 v82, v82
    v_rcp_f32 v83, v83
    v_mul_f32 v132, v132, v68
    v_mul_f32 v133, v133, v69
    v_mul_f32 v134, v134, v70
    v_mul_f32 v135, v135, v71
    v_mul_f32 v136, v136, v72
    v_mul_f32 v137, v137, v73
    v_mul_f32 v138, v138, v74
    v_mul_f32 v139, v139, v75
    v_mul_f32 v140, v140, v76
    v_mul_f32 v141, v141, v77
    v_mul_f32 v142, v142, v78
    v_mul_f32 v143, v143, v79
    v_mul_f32 v144, v144, v80
    v_mul_f32 v145, v145, v81
    v_mul_f32 v146, v146, v82
    v_mul_f32 v147, v147, v83
    v_cvt_pk_bf16_f32 v148, v132, v133
    v_cvt_pk_bf16_f32 v149, v134, v135
    v_cvt_pk_bf16_f32 v150, v136, v137
    v_cvt_pk_bf16_f32 v151, v138, v139
    v_cvt_pk_bf16_f32 v152, v140, v141
    v_cvt_pk_bf16_f32 v153, v142, v143
    v_cvt_pk_bf16_f32 v154, v144, v145
    v_cvt_pk_bf16_f32 v155, v146, v147
    s_branch K2_PC
K2_R0:
    ds_write_b128 v3, v[100:103] offset:20480
    ds_write_b128 v3, v[104:107] offset:21504
    ds_write_b128 v3, v[108:111] offset:22528
    ds_write_b128 v3, v[112:115] offset:23552
    ds_write_b128 v3, v[116:119] offset:28672
    ds_write_b128 v3, v[120:123] offset:29696
    ds_write_b128 v3, v[124:127] offset:30720
    ds_write_b128 v3, v[128:131] offset:31744
    ds_write_b128 v3, v[132:135] offset:36864
    ds_write_b128 v3, v[136:139] offset:37888
    ds_write_b128 v3, v[140:143] offset:38912
    ds_write_b128 v3, v[144:147] offset:39936
    v_lshlrev_b32 v68, 16, v148
    v_and_b32 v69, 0xffff0000, v148
    v_lshlrev_b32 v70, 16, v149
    v_and_b32 v71, 0xffff0000, v149
    v_lshlrev_b32 v72, 16, v150
    v_and_b32 v73, 0xffff0000, v150
    v_lshlrev_b32 v74, 16, v151
    v_and_b32 v75, 0xffff0000, v151
    v_lshlrev_b32 v76, 16, v152
    v_and_b32 v77, 0xffff0000, v152
    v_lshlrev_b32 v78, 16, v153
    v_and_b32 v79, 0xffff0000, v153
    v_lshlrev_b32 v80, 16, v154
    v_and_b32 v81, 0xffff0000, v154
    v_lshlrev_b32 v82, 16, v155
    v_and_b32 v83, 0xffff0000, v155
    v_add_f32 v84, v84, v68
    v_add_f32 v85, v85, v69
    v_add_f32 v86, v86, v70
    v_add_f32 v87, v87, v71
    v_add_f32 v88, v88, v72
    v_add_f32 v89, v89, v73
    v_add_f32 v90, v90, v74
    v_add_f32 v91, v91, v75
    v_add_f32 v92, v92, v76
    v_add_f32 v93, v93, v77
    v_add_f32 v94, v94, v78
    v_add_f32 v95, v95, v79
    v_add_f32 v96, v96, v80
    v_add_f32 v97, v97, v81
    v_add_f32 v98, v98, v82
    v_add_f32 v99, v99, v83
    s_waitcnt lgkmcnt(0)
    s_mov_b64 exec, 1
    ds_add_u32 v166, v167
    s_mov_b64 exec, -1
    s_mov_b32 s100, 0
K2_WB2:
    ds_read_b32 v165, v166
    s_add_u32 s100, s100, 1
    s_waitcnt lgkmcnt(0)
    v_readfirstlane_b32 s54, v165
    s_cmp_ge_u32 s100, 65536
    s_cbranch_scc1 K2_WB2x
    s_cmp_ge_u32 s54, 4
    s_cbranch_scc1 K2_WB2x
    s_sleep 2
    s_branch K2_WB2
K2_WB2x:
    ds_read_b128 v[100:103], v3 offset:0
    ds_read_b128 v[104:107], v3 offset:1024
    ds_read_b128 v[108:111], v3 offset:2048
    ds_read_b128 v[112:115], v3 offset:3072
    ds_read_b128 v[116:119], v3 offset:4096
    ds_read_b128 v[120:123], v3 offset:5120
    ds_read_b128 v[124:127], v3 offset:6144
    ds_read_b128 v[128:131], v3 offset:7168
    ds_read_b128 v[132:135], v3 offset:8192
    ds_read_b128 v[136:139], v3 offset:9216
    ds_read_b128 v[140:143], v3 offset:10240
    ds_read_b128 v[144:147], v3 offset:11264
    s_waitcnt lgkmcnt(8)
    v_add_f32 v84, v84, v100
    v_add_f32 v85, v85, v101
    v_add_f32 v86, v86, v102
    v_add_f32 v87, v87, v103
    v_add_f32 v88, v88, v104
    v_add_f32 v89, v89, v105
    v_add_f32 v90, v90, v106
    v_add_f32 v91, v91, v107
    v_add_f32 v92, v92, v108
    v_add_f32 v93, v93, v109
    v_add_f32 v94, v94, v110
    v_add_f32 v95, v95, v111
    v_add_f32 v96, v96, v112
    v_add_f32 v97, v97, v113
    v_add_f32 v98, v98, v114
    v_add_f32 v99, v99, v115
    s_waitcnt lgkmcnt(4)
    v_add_f32 v84, v84, v116
    v_add_f32 v85, v85, v117
    v_add_f32 v86, v86, v118
    v_add_f32 v87, v87, v119
    v_add_f32 v88, v88, v120
    v_add_f32 v89, v89, v121
    v_add_f32 v90, v90, v122
    v_add_f32 v91, v91, v123
    v_add_f32 v92, v92, v124
    v_add_f32 v93, v93, v125
    v_add_f32 v94, v94, v126
    v_add_f32 v95, v95, v127
    v_add_f32 v96, v96, v128
    v_add_f32 v97, v97, v129
    v_add_f32 v98, v98, v130
    v_add_f32 v99, v99, v131
    s_waitcnt lgkmcnt(0)
    v_add_f32 v84, v84, v132
    v_add_f32 v85, v85, v133
    v_add_f32 v86, v86, v134
    v_add_f32 v87, v87, v135
    v_add_f32 v88, v88, v136
    v_add_f32 v89, v89, v137
    v_add_f32 v90, v90, v138
    v_add_f32 v91, v91, v139
    v_add_f32 v92, v92, v140
    v_add_f32 v93, v93, v141
    v_add_f32 v94, v94, v142
    v_add_f32 v95, v95, v143
    v_add_f32 v96, v96, v144
    v_add_f32 v97, v97, v145
    v_add_f32 v98, v98, v146
    v_add_f32 v99, v99, v147
    v_mul_f32 v68, 0xbfb8aa3b, v84
    v_mul_f32 v69, 0xbfb8aa3b, v85
    v_mul_f32 v70, 0xbfb8aa3b, v86
    v_mul_f32 v71, 0xbfb8aa3b, v87
    v_mul_f32 v72, 0xbfb8aa3b, v88
    v_mul_f32 v73, 0xbfb8aa3b, v89
    v_mul_f32 v74, 0xbfb8aa3b, v90
    v_mul_f32 v75, 0xbfb8aa3b, v91
    v_mul_f32 v76, 0xbfb8aa3b, v92
    v_mul_f32 v77, 0xbfb8aa3b, v93
    v_mul_f32 v78, 0xbfb8aa3b, v94
    v_mul_f32 v79, 0xbfb8aa3b, v95
    v_mul_f32 v80, 0xbfb8aa3b, v96
    v_mul_f32 v81, 0xbfb8aa3b, v97
    v_mul_f32 v82, 0xbfb8aa3b, v98
    v_mul_f32 v83, 0xbfb8aa3b, v99
    v_exp_f32 v68, v68
    v_exp_f32 v69, v69
    v_exp_f32 v70, v70
    v_exp_f32 v71, v71
    v_exp_f32 v72, v72
    v_exp_f32 v73, v73
    v_exp_f32 v74, v74
    v_exp_f32 v75, v75
    v_exp_f32 v76, v76
    v_exp_f32 v77, v77
    v_exp_f32 v78, v78
    v_exp_f32 v79, v79
    v_exp_f32 v80, v80
    v_exp_f32 v81, v81
    v_exp_f32 v82, v82
    v_exp_f32 v83, v83
    v_add_f32 v68, 1.0, v68
    v_add_f32 v69, 1.0, v69
    v_add_f32 v70, 1.0, v70
    v_add_f32 v71, 1.0, v71
    v_add_f32 v72, 1.0, v72
    v_add_f32 v73, 1.0, v73
    v_add_f32 v74, 1.0, v74
    v_add_f32 v75, 1.0, v75
    v_add_f32 v76, 1.0, v76
    v_add_f32 v77, 1.0, v77
    v_add_f32 v78, 1.0, v78
    v_add_f32 v79, 1.0, v79
    v_add_f32 v80, 1.0, v80
    v_add_f32 v81, 1.0, v81
    v_add_f32 v82, 1.0, v82
    v_add_f32 v83, 1.0, v83
    v_rcp_f32 v68, v68
    v_rcp_f32 v69, v69
    v_rcp_f32 v70, v70
    v_rcp_f32 v71, v71
    v_rcp_f32 v72, v72
    v_rcp_f32 v73, v73
    v_rcp_f32 v74, v74
    v_rcp_f32 v75, v75
    v_rcp_f32 v76, v76
    v_rcp_f32 v77, v77
    v_rcp_f32 v78, v78
    v_rcp_f32 v79, v79
    v_rcp_f32 v80, v80
    v_rcp_f32 v81, v81
    v_rcp_f32 v82, v82
    v_rcp_f32 v83, v83
    v_mul_f32 v84, v84, v68
    v_mul_f32 v85, v85, v69
    v_mul_f32 v86, v86, v70
    v_mul_f32 v87, v87, v71
    v_mul_f32 v88, v88, v72
    v_mul_f32 v89, v89, v73
    v_mul_f32 v90, v90, v74
    v_mul_f32 v91, v91, v75
    v_mul_f32 v92, v92, v76
    v_mul_f32 v93, v93, v77
    v_mul_f32 v94, v94, v78
    v_mul_f32 v95, v95, v79
    v_mul_f32 v96, v96, v80
    v_mul_f32 v97, v97, v81
    v_mul_f32 v98, v98, v82
    v_mul_f32 v99, v99, v83
    v_cvt_pk_bf16_f32 v148, v84, v85
    v_cvt_pk_bf16_f32 v149, v86, v87
    v_cvt_pk_bf16_f32 v150, v88, v89
    v_cvt_pk_bf16_f32 v151, v90, v91
    v_cvt_pk_bf16_f32 v152, v92, v93
    v_cvt_pk_bf16_f32 v153, v94, v95
    v_cvt_pk_bf16_f32 v154, v96, v97
    v_cvt_pk_bf16_f32 v155, v98, v99
    s_branch K2_PC
K2_R1:
    ds_write_b128 v3, v[84:87] offset:0
    ds_write_b128 v3, v[88:91] offset:1024
    ds_write_b128 v3, v[92:95] offset:2048
    ds_write_b128 v3, v[96:99] offset:3072
    ds_write_b128 v3, v[116:119] offset:32768
    ds_write_b128 v3, v[120:123] offset:33792
    ds_write_b128 v3, v[124:127] offset:34816
    ds_write_b128 v3, v[128:131] offset:35840
    ds_write_b128 v3, v[132:135] offset:40960
    ds_write_b128 v3, v[136:139] offset:41984
    ds_write_b128 v3, v[140:143] offset:43008
    ds_write_b128 v3, v[144:147] offset:44032
    v_lshlrev_b32 v68, 16, v148
    v_and_b32 v69, 0xffff0000, v148
    v_lshlrev_b32 v70, 16, v149
    v_and_b32 v71, 0xffff0000, v149
    v_lshlrev_b32 v72, 16, v150
    v_and_b32 v73, 0xffff0000, v150
    v_lshlrev_b32 v74, 16, v151
    v_and_b32 v75, 0xffff0000, v151
    v_lshlrev_b32 v76, 16, v152
    v_and_b32 v77, 0xffff0000, v152
    v_lshlrev_b32 v78, 16, v153
    v_and_b32 v79, 0xffff0000, v153
    v_lshlrev_b32 v80, 16, v154
    v_and_b32 v81, 0xffff0000, v154
    v_lshlrev_b32 v82, 16, v155
    v_and_b32 v83, 0xffff0000, v155
    v_add_f32 v100, v100, v68
    v_add_f32 v101, v101, v69
    v_add_f32 v102, v102, v70
    v_add_f32 v103, v103, v71
    v_add_f32 v104, v104, v72
    v_add_f32 v105, v105, v73
    v_add_f32 v106, v106, v74
    v_add_f32 v107, v107, v75
    v_add_f32 v108, v108, v76
    v_add_f32 v109, v109, v77
    v_add_f32 v110, v110, v78
    v_add_f32 v111, v111, v79
    v_add_f32 v112, v112, v80
    v_add_f32 v113, v113, v81
    v_add_f32 v114, v114, v82
    v_add_f32 v115, v115, v83
    s_waitcnt lgkmcnt(0)
    s_mov_b64 exec, 1
    ds_add_u32 v166, v167
    s_mov_b64 exec, -1
    s_mov_b32 s100, 0
K2_WB3:
    ds_read_b32 v165, v166
    s_add_u32 s100, s100, 1
    s_waitcnt lgkmcnt(0)
    v_readfirstlane_b32 s54, v165
    s_cmp_ge_u32 s100, 65536
    s_cbranch_scc1 K2_WB3x
    s_cmp_ge_u32 s54, 4
    s_cbranch_scc1 K2_WB3x
    s_sleep 2
    s_branch K2_WB3
K2_WB3x:
    ds_read_b128 v[84:87], v3 offset:12288
    ds_read_b128 v[88:91], v3 offset:13312
    ds_read_b128 v[92:95], v3 offset:14336
    ds_read_b128 v[96:99], v3 offset:15360
    ds_read_b128 v[116:119], v3 offset:16384
    ds_read_b128 v[120:123], v3 offset:17408
    ds_read_b128 v[124:127], v3 offset:18432
    ds_read_b128 v[128:131], v3 offset:19456
    ds_read_b128 v[132:135], v3 offset:20480
    ds_read_b128 v[136:139], v3 offset:21504
    ds_read_b128 v[140:143], v3 offset:22528
    ds_read_b128 v[144:147], v3 offset:23552
    s_waitcnt lgkmcnt(8)
    v_add_f32 v100, v100, v84
    v_add_f32 v101, v101, v85
    v_add_f32 v102, v102, v86
    v_add_f32 v103, v103, v87
    v_add_f32 v104, v104, v88
    v_add_f32 v105, v105, v89
    v_add_f32 v106, v106, v90
    v_add_f32 v107, v107, v91
    v_add_f32 v108, v108, v92
    v_add_f32 v109, v109, v93
    v_add_f32 v110, v110, v94
    v_add_f32 v111, v111, v95
    v_add_f32 v112, v112, v96
    v_add_f32 v113, v113, v97
    v_add_f32 v114, v114, v98
    v_add_f32 v115, v115, v99
    s_waitcnt lgkmcnt(4)
    v_add_f32 v100, v100, v116
    v_add_f32 v101, v101, v117
    v_add_f32 v102, v102, v118
    v_add_f32 v103, v103, v119
    v_add_f32 v104, v104, v120
    v_add_f32 v105, v105, v121
    v_add_f32 v106, v106, v122
    v_add_f32 v107, v107, v123
    v_add_f32 v108, v108, v124
    v_add_f32 v109, v109, v125
    v_add_f32 v110, v110, v126
    v_add_f32 v111, v111, v127
    v_add_f32 v112, v112, v128
    v_add_f32 v113, v113, v129
    v_add_f32 v114, v114, v130
    v_add_f32 v115, v115, v131
    s_waitcnt lgkmcnt(0)
    v_add_f32 v100, v100, v132
    v_add_f32 v101, v101, v133
    v_add_f32 v102, v102, v134
    v_add_f32 v103, v103, v135
    v_add_f32 v104, v104, v136
    v_add_f32 v105, v105, v137
    v_add_f32 v106, v106, v138
    v_add_f32 v107, v107, v139
    v_add_f32 v108, v108, v140
    v_add_f32 v109, v109, v141
    v_add_f32 v110, v110, v142
    v_add_f32 v111, v111, v143
    v_add_f32 v112, v112, v144
    v_add_f32 v113, v113, v145
    v_add_f32 v114, v114, v146
    v_add_f32 v115, v115, v147
    v_mul_f32 v68, 0xbfb8aa3b, v100
    v_mul_f32 v69, 0xbfb8aa3b, v101
    v_mul_f32 v70, 0xbfb8aa3b, v102
    v_mul_f32 v71, 0xbfb8aa3b, v103
    v_mul_f32 v72, 0xbfb8aa3b, v104
    v_mul_f32 v73, 0xbfb8aa3b, v105
    v_mul_f32 v74, 0xbfb8aa3b, v106
    v_mul_f32 v75, 0xbfb8aa3b, v107
    v_mul_f32 v76, 0xbfb8aa3b, v108
    v_mul_f32 v77, 0xbfb8aa3b, v109
    v_mul_f32 v78, 0xbfb8aa3b, v110
    v_mul_f32 v79, 0xbfb8aa3b, v111
    v_mul_f32 v80, 0xbfb8aa3b, v112
    v_mul_f32 v81, 0xbfb8aa3b, v113
    v_mul_f32 v82, 0xbfb8aa3b, v114
    v_mul_f32 v83, 0xbfb8aa3b, v115
    v_exp_f32 v68, v68
    v_exp_f32 v69, v69
    v_exp_f32 v70, v70
    v_exp_f32 v71, v71
    v_exp_f32 v72, v72
    v_exp_f32 v73, v73
    v_exp_f32 v74, v74
    v_exp_f32 v75, v75
    v_exp_f32 v76, v76
    v_exp_f32 v77, v77
    v_exp_f32 v78, v78
    v_exp_f32 v79, v79
    v_exp_f32 v80, v80
    v_exp_f32 v81, v81
    v_exp_f32 v82, v82
    v_exp_f32 v83, v83
    v_add_f32 v68, 1.0, v68
    v_add_f32 v69, 1.0, v69
    v_add_f32 v70, 1.0, v70
    v_add_f32 v71, 1.0, v71
    v_add_f32 v72, 1.0, v72
    v_add_f32 v73, 1.0, v73
    v_add_f32 v74, 1.0, v74
    v_add_f32 v75, 1.0, v75
    v_add_f32 v76, 1.0, v76
    v_add_f32 v77, 1.0, v77
    v_add_f32 v78, 1.0, v78
    v_add_f32 v79, 1.0, v79
    v_add_f32 v80, 1.0, v80
    v_add_f32 v81, 1.0, v81
    v_add_f32 v82, 1.0, v82
    v_add_f32 v83, 1.0, v83
    v_rcp_f32 v68, v68
    v_rcp_f32 v69, v69
    v_rcp_f32 v70, v70
    v_rcp_f32 v71, v71
    v_rcp_f32 v72, v72
    v_rcp_f32 v73, v73
    v_rcp_f32 v74, v74
    v_rcp_f32 v75, v75
    v_rcp_f32 v76, v76
    v_rcp_f32 v77, v77
    v_rcp_f32 v78, v78
    v_rcp_f32 v79, v79
    v_rcp_f32 v80, v80
    v_rcp_f32 v81, v81
    v_rcp_f32 v82, v82
    v_rcp_f32 v83, v83
    v_mul_f32 v100, v100, v68
    v_mul_f32 v101, v101, v69
    v_mul_f32 v102, v102, v70
    v_mul_f32 v103, v103, v71
    v_mul_f32 v104, v104, v72
    v_mul_f32 v105, v105, v73
    v_mul_f32 v106, v106, v74
    v_mul_f32 v107, v107, v75
    v_mul_f32 v108, v108, v76
    v_mul_f32 v109, v109, v77
    v_mul_f32 v110, v110, v78
    v_mul_f32 v111, v111, v79
    v_mul_f32 v112, v112, v80
    v_mul_f32 v113, v113, v81
    v_mul_f32 v114, v114, v82
    v_mul_f32 v115, v115, v83
    v_cvt_pk_bf16_f32 v148, v100, v101
    v_cvt_pk_bf16_f32 v149, v102, v103
    v_cvt_pk_bf16_f32 v150, v104, v105
    v_cvt_pk_bf16_f32 v151, v106, v107
    v_cvt_pk_bf16_f32 v152, v108, v109
    v_cvt_pk_bf16_f32 v153, v110, v111
    v_cvt_pk_bf16_f32 v154, v112, v113
    v_cvt_pk_bf16_f32 v155, v114, v115
    s_branch K2_PC
K2_R2:
    ds_write_b128 v3, v[84:87] offset:4096
    ds_write_b128 v3, v[88:91] offset:5120
    ds_write_b128 v3, v[92:95] offset:6144
    ds_write_b128 v3, v[96:99] offset:7168
    ds_write_b128 v3, v[100:103] offset:12288
    ds_write_b128 v3, v[104:107] offset:13312
    ds_write_b128 v3, v[108:111] offset:14336
    ds_write_b128 v3, v[112:115] offset:15360
    ds_write_b128 v3, v[132:135] offset:45056
    ds_write_b128 v3, v[136:139] offset:46080
    ds_write_b128 v3, v[140:143] offset:47104
    ds_write_b128 v3, v[144:147] offset:48128
    v_lshlrev_b32 v68, 16, v148
    v_and_b32 v69, 0xffff0000, v148
    v_lshlrev_b32 v70, 16, v149
    v_and_b32 v71, 0xffff0000, v149
    v_lshlrev_b32 v72, 16, v150
    v_and_b32 v73, 0xffff0000, v150
    v_lshlrev_b32 v74, 16, v151
    v_and_b32 v75, 0xffff0000, v151
    v_lshlrev_b32 v76, 16, v152
    v_and_b32 v77, 0xffff0000, v152
    v_lshlrev_b32 v78, 16, v153
    v_and_b32 v79, 0xffff0000, v153
    v_lshlrev_b32 v80, 16, v154
    v_and_b32 v81, 0xffff0000, v154
    v_lshlrev_b32 v82, 16, v155
    v_and_b32 v83, 0xffff0000, v155
    v_add_f32 v116, v116, v68
    v_add_f32 v117, v117, v69
    v_add_f32 v118, v118, v70
    v_add_f32 v119, v119, v71
    v_add_f32 v120, v120, v72
    v_add_f32 v121, v121, v73
    v_add_f32 v122, v122, v74
    v_add_f32 v123, v123, v75
    v_add_f32 v124, v124, v76
    v_add_f32 v125, v125, v77
    v_add_f32 v126, v126, v78
    v_add_f32 v127, v127, v79
    v_add_f32 v128, v128, v80
    v_add_f32 v129, v129, v81
    v_add_f32 v130, v130, v82
    v_add_f32 v131, v131, v83
    s_waitcnt lgkmcnt(0)
    s_mov_b64 exec, 1
    ds_add_u32 v166, v167
    s_mov_b64 exec, -1
    s_mov_b32 s100, 0
K2_WB4:
    ds_read_b32 v165, v166
    s_add_u32 s100, s100, 1
    s_waitcnt lgkmcnt(0)
    v_readfirstlane_b32 s54, v165
    s_cmp_ge_u32 s100, 65536
    s_cbranch_scc1 K2_WB4x
    s_cmp_ge_u32 s54, 4
    s_cbranch_scc1 K2_WB4x
    s_sleep 2
    s_branch K2_WB4
K2_WB4x:
    ds_read_b128 v[84:87], v3 offset:24576
    ds_read_b128 v[88:91], v3 offset:25600
    ds_read_b128 v[92:95], v3 offset:26624
    ds_read_b128 v[96:99], v3 offset:27648
    ds_read_b128 v[100:103], v3 offset:28672
    ds_read_b128 v[104:107], v3 offset:29696
    ds_read_b128 v[108:111], v3 offset:30720
    ds_read_b128 v[112:115], v3 offset:31744
    ds_read_b128 v[132:135], v3 offset:32768
    ds_read_b128 v[136:139], v3 offset:33792
    ds_read_b128 v[140:143], v3 offset:34816
    ds_read_b128 v[144:147], v3 offset:35840
    s_waitcnt lgkmcnt(8)
    v_add_f32 v116, v116, v84
    v_add_f32 v117, v117, v85
    v_add_f32 v118, v118, v86
    v_add_f32 v119, v119, v87
    v_add_f32 v120, v120, v88
    v_add_f32 v121, v121, v89
    v_add_f32 v122, v122, v90
    v_add_f32 v123, v123, v91
    v_add_f32 v124, v124, v92
    v_add_f32 v125, v125, v93
    v_add_f32 v126, v126, v94
    v_add_f32 v127, v127, v95
    v_add_f32 v128, v128, v96
    v_add_f32 v129, v129, v97
    v_add_f32 v130, v130, v98
    v_add_f32 v131, v131, v99
    s_waitcnt lgkmcnt(4)
    v_add_f32 v116, v116, v100
    v_add_f32 v117, v117, v101
    v_add_f32 v118, v118, v102
    v_add_f32 v119, v119, v103
    v_add_f32 v120, v120, v104
    v_add_f32 v121, v121, v105
    v_add_f32 v122, v122, v106
    v_add_f32 v123, v123, v107
    v_add_f32 v124, v124, v108
    v_add_f32 v125, v125, v109
    v_add_f32 v126, v126, v110
    v_add_f32 v127, v127, v111
    v_add_f32 v128, v128, v112
    v_add_f32 v129, v129, v113
    v_add_f32 v130, v130, v114
    v_add_f32 v131, v131, v115
    s_waitcnt lgkmcnt(0)
    v_add_f32 v116, v116, v132
    v_add_f32 v117, v117, v133
    v_add_f32 v118, v118, v134
    v_add_f32 v119, v119, v135
    v_add_f32 v120, v120, v136
    v_add_f32 v121, v121, v137
    v_add_f32 v122, v122, v138
    v_add_f32 v123, v123, v139
    v_add_f32 v124, v124, v140
    v_add_f32 v125, v125, v141
    v_add_f32 v126, v126, v142
    v_add_f32 v127, v127, v143
    v_add_f32 v128, v128, v144
    v_add_f32 v129, v129, v145
    v_add_f32 v130, v130, v146
    v_add_f32 v131, v131, v147
    v_mul_f32 v68, 0xbfb8aa3b, v116
    v_mul_f32 v69, 0xbfb8aa3b, v117
    v_mul_f32 v70, 0xbfb8aa3b, v118
    v_mul_f32 v71, 0xbfb8aa3b, v119
    v_mul_f32 v72, 0xbfb8aa3b, v120
    v_mul_f32 v73, 0xbfb8aa3b, v121
    v_mul_f32 v74, 0xbfb8aa3b, v122
    v_mul_f32 v75, 0xbfb8aa3b, v123
    v_mul_f32 v76, 0xbfb8aa3b, v124
    v_mul_f32 v77, 0xbfb8aa3b, v125
    v_mul_f32 v78, 0xbfb8aa3b, v126
    v_mul_f32 v79, 0xbfb8aa3b, v127
    v_mul_f32 v80, 0xbfb8aa3b, v128
    v_mul_f32 v81, 0xbfb8aa3b, v129
    v_mul_f32 v82, 0xbfb8aa3b, v130
    v_mul_f32 v83, 0xbfb8aa3b, v131
    v_exp_f32 v68, v68
    v_exp_f32 v69, v69
    v_exp_f32 v70, v70
    v_exp_f32 v71, v71
    v_exp_f32 v72, v72
    v_exp_f32 v73, v73
    v_exp_f32 v74, v74
    v_exp_f32 v75, v75
    v_exp_f32 v76, v76
    v_exp_f32 v77, v77
    v_exp_f32 v78, v78
    v_exp_f32 v79, v79
    v_exp_f32 v80, v80
    v_exp_f32 v81, v81
    v_exp_f32 v82, v82
    v_exp_f32 v83, v83
    v_add_f32 v68, 1.0, v68
    v_add_f32 v69, 1.0, v69
    v_add_f32 v70, 1.0, v70
    v_add_f32 v71, 1.0, v71
    v_add_f32 v72, 1.0, v72
    v_add_f32 v73, 1.0, v73
    v_add_f32 v74, 1.0, v74
    v_add_f32 v75, 1.0, v75
    v_add_f32 v76, 1.0, v76
    v_add_f32 v77, 1.0, v77
    v_add_f32 v78, 1.0, v78
    v_add_f32 v79, 1.0, v79
    v_add_f32 v80, 1.0, v80
    v_add_f32 v81, 1.0, v81
    v_add_f32 v82, 1.0, v82
    v_add_f32 v83, 1.0, v83
    v_rcp_f32 v68, v68
    v_rcp_f32 v69, v69
    v_rcp_f32 v70, v70
    v_rcp_f32 v71, v71
    v_rcp_f32 v72, v72
    v_rcp_f32 v73, v73
    v_rcp_f32 v74, v74
    v_rcp_f32 v75, v75
    v_rcp_f32 v76, v76
    v_rcp_f32 v77, v77
    v_rcp_f32 v78, v78
    v_rcp_f32 v79, v79
    v_rcp_f32 v80, v80
    v_rcp_f32 v81, v81
    v_rcp_f32 v82, v82
    v_rcp_f32 v83, v83
    v_mul_f32 v116, v116, v68
    v_mul_f32 v117, v117, v69
    v_mul_f32 v118, v118, v70
    v_mul_f32 v119, v119, v71
    v_mul_f32 v120, v120, v72
    v_mul_f32 v121, v121, v73
    v_mul_f32 v122, v122, v74
    v_mul_f32 v123, v123, v75
    v_mul_f32 v124, v124, v76
    v_mul_f32 v125, v125, v77
    v_mul_f32 v126, v126, v78
    v_mul_f32 v127, v127, v79
    v_mul_f32 v128, v128, v80
    v_mul_f32 v129, v129, v81
    v_mul_f32 v130, v130, v82
    v_mul_f32 v131, v131, v83
    v_cvt_pk_bf16_f32 v148, v116, v117
    v_cvt_pk_bf16_f32 v149, v118, v119
    v_cvt_pk_bf16_f32 v150, v120, v121
    v_cvt_pk_bf16_f32 v151, v122, v123
    v_cvt_pk_bf16_f32 v152, v124, v125
    v_cvt_pk_bf16_f32 v153, v126, v127
    v_cvt_pk_bf16_f32 v154, v128, v129
    v_cvt_pk_bf16_f32 v155, v130, v131
K2_PC:
    s_lshl_b32 s55, s49, 14
    s_add_u32 s55, s55, 69632
    v_add_u32 v165, s55, v2
    s_mov_b32 s101, s55
    v_and_b32 v167, 7, v1
    v_mul_u32_u24 v167, 16, v167
    s_mov_b32 s100, 0
    s_barrier
K2_FP:
    buffer_load_dword v166, v167, s[28:31], s93 offen sc1
    s_add_u32 s100, s100, 1
    s_waitcnt vmcnt(0)
    v_cmp_ne_u32 vcc, s71, v166
    s_cmp_ge_u32 s100, 65536
    s_cbranch_scc1 K2_FPX
    s_cbranch_vccz K2_FPX
    s_sleep 1
    s_branch K2_FP
K2_FPX:
    s_add_u32 m0, s101, 0
    s_add_u32 s54, s95, 0
    buffer_load_dwordx4 v2, s[28:31], s54 offen sc1 lds
    s_add_u32 m0, s101, 1024
    s_add_u32 s54, s3, 0
    buffer_load_dwordx4 v2, s[28:31], s54 offen sc1 lds
    s_add_u32 m0, s101, 2048
    s_add_u32 s54, s95, 1024
    buffer_load_dwordx4 v2, s[28:31], s54 offen sc1 lds
    s_add_u32 m0, s101, 3072
    s_add_u32 s54, s3, 1024
    buffer_load_dwordx4 v2, s[28:31], s54 offen sc1 lds
    s_add_u32 m0, s101, 4096
    s_add_u32 s54, s95, 2048
    buffer_load_dwordx4 v2, s[28:31], s54 offen sc1 lds
    s_add_u32 m0, s101, 5120
    s_add_u32 s54, s3, 2048
    buffer_load_dwordx4 v2, s[28:31], s54 offen sc1 lds
    s_add_u32 m0, s101, 6144
    s_add_u32 s54, s95, 3072
    buffer_load_dwordx4 v2, s[28:31], s54 offen sc1 lds
    s_add_u32 m0, s101, 7168
    s_add_u32 s54, s3, 3072
    buffer_load_dwordx4 v2, s[28:31], s54 offen sc1 lds
    s_add_u32 m0, s101, 8192
    s_add_u32 s54, s95, 4096
    buffer_load_dwordx4 v2, s[28:31], s54 offen sc1 lds
    s_add_u32 m0, s101, 9216
    s_add_u32 s54, s3, 4096
    buffer_load_dwordx4 v2, s[28:31], s54 offen sc1 lds
    s_add_u32 m0, s101, 10240
    s_add_u32 s54, s95, 5120
    buffer_load_dwordx4 v2, s[28:31], s54 offen sc1 lds
    s_add_u32 m0, s101, 11264
    s_add_u32 s54, s3, 5120
    buffer_load_dwordx4 v2, s[28:31], s54 offen sc1 lds
    s_add_u32 m0, s101, 12288
    s_add_u32 s54, s95, 6144
    buffer_load_dwordx4 v2, s[28:31], s54 offen sc1 lds
    s_add_u32 m0, s101, 13312
    s_add_u32 s54, s3, 6144
    buffer_load_dwordx4 v2, s[28:31], s54 offen sc1 lds
    s_add_u32 m0, s101, 14336
    s_add_u32 s54, s95, 7168
    buffer_load_dwordx4 v2, s[28:31], s54 offen sc1 lds
    s_add_u32 m0, s101, 15360
    s_add_u32 s54, s3, 7168
    buffer_load_dwordx4 v2, s[28:31], s54 offen sc1 lds
    s_waitcnt vmcnt(14)
    ds_read_b128 v[68:71], v165 offset:0
    ds_read_b128 v[72:75], v165 offset:1024
    s_waitcnt vmcnt(12)
    ds_read_b128 v[76:79], v165 offset:2048
    ds_read_b128 v[80:83], v165 offset:3072
    s_waitcnt lgkmcnt(2)
    v_mfma_f32_32x32x16_bf16 v[84:99], v[4:7], v[68:71], 0
    v_mfma_f32_32x32x16_bf16 v[100:115], v[4:7], v[72:75], 0
    v_mfma_f32_32x32x16_bf16 v[116:131], v[8:11], v[68:71], 0
    v_mfma_f32_32x32x16_bf16 v[132:147], v[8:11], v[72:75], 0
    s_waitcnt vmcnt(10)
    ds_read_b128 v[68:71], v165 offset:4096
    ds_read_b128 v[72:75], v165 offset:5120
    s_waitcnt lgkmcnt(2)
    v_mfma_f32_32x32x16_bf16 v[84:99], v[12:15], v[76:79], v[84:99]
    v_mfma_f32_32x32x16_bf16 v[100:115], v[12:15], v[80:83], v[100:115]
    v_mfma_f32_32x32x16_bf16 v[116:131], v[16:19], v[76:79], v[116:131]
    v_mfma_f32_32x32x16_bf16 v[132:147], v[16:19], v[80:83], v[132:147]
    s_waitcnt vmcnt(8)
    ds_read_b128 v[76:79], v165 offset:6144
    ds_read_b128 v[80:83], v165 offset:7168
    s_waitcnt lgkmcnt(2)
    v_mfma_f32_32x32x16_bf16 v[84:99], v[20:23], v[68:71], v[84:99]
    v_mfma_f32_32x32x16_bf16 v[100:115], v[20:23], v[72:75], v[100:115]
    v_mfma_f32_32x32x16_bf16 v[116:131], v[24:27], v[68:71], v[116:131]
    v_mfma_f32_32x32x16_bf16 v[132:147], v[24:27], v[72:75], v[132:147]
    s_waitcnt vmcnt(6)
    ds_read_b128 v[68:71], v165 offset:8192
    ds_read_b128 v[72:75], v165 offset:9216
    s_waitcnt lgkmcnt(2)
    v_mfma_f32_32x32x16_bf16 v[84:99], v[28:31], v[76:79], v[84:99]
    v_mfma_f32_32x32x16_bf16 v[100:115], v[28:31], v[80:83], v[100:115]
    v_mfma_f32_32x32x16_bf16 v[116:131], v[32:35], v[76:79], v[116:131]
    v_mfma_f32_32x32x16_bf16 v[132:147], v[32:35], v[80:83], v[132:147]
    s_waitcnt vmcnt(4)
    ds_read_b128 v[76:79], v165 offset:10240
    ds_read_b128 v[80:83], v165 offset:11264
    s_waitcnt lgkmcnt(2)
    v_mfma_f32_32x32x16_bf16 v[84:99], v[36:39], v[68:71], v[84:99]
    v_mfma_f32_32x32x16_bf16 v[100:115], v[36:39], v[72:75], v[100:115]
    v_mfma_f32_32x32x16_bf16 v[116:131], v[40:43], v[68:71], v[116:131]
    v_mfma_f32_32x32x16_bf16 v[132:147], v[40:43], v[72:75], v[132:147]
    s_waitcnt vmcnt(2)
    ds_read_b128 v[68:71], v165 offset:12288
    ds_read_b128 v[72:75], v165 offset:13312
    s_waitcnt lgkmcnt(2)
    v_mfma_f32_32x32x16_bf16 v[84:99], v[44:47], v[76:79], v[84:99]
    v_mfma_f32_32x32x16_bf16 v[100:115], v[44:47], v[80:83], v[100:115]
    v_mfma_f32_32x32x16_bf16 v[116:131], v[48:51], v[76:79], v[116:131]
    v_mfma_f32_32x32x16_bf16 v[132:147], v[48:51], v[80:83], v[132:147]
    s_waitcnt vmcnt(0)
    ds_read_b128 v[76:79], v165 offset:14336
    ds_read_b128 v[80:83], v165 offset:15360
    s_waitcnt lgkmcnt(2)
    v_mfma_f32_32x32x16_bf16 v[84:99], v[52:55], v[68:71], v[84:99]
    v_mfma_f32_32x32x16_bf16 v[100:115], v[52:55], v[72:75], v[100:115]
    v_mfma_f32_32x32x16_bf16 v[116:131], v[56:59], v[68:71], v[116:131]
    v_mfma_f32_32x32x16_bf16 v[132:147], v[56:59], v[72:75], v[132:147]
    s_waitcnt lgkmcnt(0)
    v_mfma_f32_32x32x16_bf16 v[84:99], v[60:63], v[76:79], v[84:99]
    v_mfma_f32_32x32x16_bf16 v[100:115], v[60:63], v[80:83], v[100:115]
    v_mfma_f32_32x32x16_bf16 v[116:131], v[64:67], v[76:79], v[116:131]
    v_mfma_f32_32x32x16_bf16 v[132:147], v[64:67], v[80:83], v[132:147]
    v_add_u32 v3, 20480, v2
    s_nop 7
    s_nop 7
    s_cmp_eq_u32 s49, 0
    s_cbranch_scc1 K2_C0
    s_cmp_eq_u32 s49, 1
    s_cbranch_scc1 K2_C1
    s_cmp_eq_u32 s49, 2
    s_cbranch_scc1 K2_C2
    ds_write_b128 v3, v[84:87] offset:8192
    ds_write_b128 v3, v[88:91] offset:9216
    ds_write_b128 v3, v[92:95] offset:10240
    ds_write_b128 v3, v[96:99] offset:11264
    ds_write_b128 v3, v[100:103] offset:16384
    ds_write_b128 v3, v[104:107] offset:17408
    ds_write_b128 v3, v[108:111] offset:18432
    ds_write_b128 v3, v[112:115] offset:19456
    ds_write_b128 v3, v[116:119] offset:24576
    ds_write_b128 v3, v[120:123] offset:25600
    ds_write_b128 v3, v[124:127] offset:26624
    ds_write_b128 v3, v[128:131] offset:27648
    s_waitcnt lgkmcnt(0)
    s_barrier
    ds_read_b128 v[4:7], v3 offset:36864
    ds_read_b128 v[8:11], v3 offset:37888
    ds_read_b128 v[12:15], v3 offset:38912
    ds_read_b128 v[16:19], v3 offset:39936
    ds_read_b128 v[20:23], v3 offset:40960
    ds_read_b128 v[24:27], v3 offset:41984
    ds_read_b128 v[28:31], v3 offset:43008
    ds_read_b128 v[32:35], v3 offset:44032
    ds_read_b128 v[36:39], v3 offset:45056
    ds_read_b128 v[40:43], v3 offset:46080
    ds_read_b128 v[44:47], v3 offset:47104
    ds_read_b128 v[48:51], v3 offset:48128
    v_lshlrev_b32 v52, 16, v148
    v_and_b32 v53, 0xffff0000, v148
    v_lshlrev_b32 v54, 16, v149
    v_and_b32 v55, 0xffff0000, v149
    v_lshlrev_b32 v56, 16, v150
    v_and_b32 v57, 0xffff0000, v150
    v_lshlrev_b32 v58, 16, v151
    v_and_b32 v59, 0xffff0000, v151
    v_lshlrev_b32 v60, 16, v152
    v_and_b32 v61, 0xffff0000, v152
    v_lshlrev_b32 v62, 16, v153
    v_and_b32 v63, 0xffff0000, v153
    v_lshlrev_b32 v64, 16, v154
    v_and_b32 v65, 0xffff0000, v154
    v_lshlrev_b32 v66, 16, v155
    v_and_b32 v67, 0xffff0000, v155
    v_lshlrev_b32 v68, 16, v156
    v_and_b32 v69, 0xffff0000, v156
    v_lshlrev_b32 v70, 16, v157
    v_and_b32 v71, 0xffff0000, v157
    v_lshlrev_b32 v72, 16, v158
    v_and_b32 v73, 0xffff0000, v158
    v_lshlrev_b32 v74, 16, v159
    v_and_b32 v75, 0xffff0000, v159
    v_lshlrev_b32 v76, 16, v160
    v_and_b32 v77, 0xffff0000, v160
    v_lshlrev_b32 v78, 16, v161
    v_and_b32 v79, 0xffff0000, v161
    v_lshlrev_b32 v80, 16, v162
    v_and_b32 v81, 0xffff0000, v162
    v_lshlrev_b32 v82, 16, v163
    v_and_b32 v83, 0xffff0000, v163
    s_waitcnt lgkmcnt(8)
    v_add_f32 v132, v132, v4
    v_add_f32 v133, v133, v5
    v_add_f32 v134, v134, v6
    v_add_f32 v135, v135, v7
    v_add_f32 v136, v136, v8
    v_add_f32 v137, v137, v9
    v_add_f32 v138, v138, v10
    v_add_f32 v139, v139, v11
    v_add_f32 v140, v140, v12
    v_add_f32 v141, v141, v13
    v_add_f32 v142, v142, v14
    v_add_f32 v143, v143, v15
    v_add_f32 v144, v144, v16
    v_add_f32 v145, v145, v17
    v_add_f32 v146, v146, v18
    v_add_f32 v147, v147, v19
    s_waitcnt lgkmcnt(4)
    v_add_f32 v132, v132, v20
    v_add_f32 v133, v133, v21
    v_add_f32 v134, v134, v22
    v_add_f32 v135, v135, v23
    v_add_f32 v136, v136, v24
    v_add_f32 v137, v137, v25
    v_add_f32 v138, v138, v26
    v_add_f32 v139, v139, v27
    v_add_f32 v140, v140, v28
    v_add_f32 v141, v141, v29
    v_add_f32 v142, v142, v30
    v_add_f32 v143, v143, v31
    v_add_f32 v144, v144, v32
    v_add_f32 v145, v145, v33
    v_add_f32 v146, v146, v34
    v_add_f32 v147, v147, v35
    s_waitcnt lgkmcnt(0)
    v_add_f32 v132, v132, v36
    v_add_f32 v133, v133, v37
    v_add_f32 v134, v134, v38
    v_add_f32 v135, v135, v39
    v_add_f32 v136, v136, v40
    v_add_f32 v137, v137, v41
    v_add_f32 v138, v138, v42
    v_add_f32 v139, v139, v43
    v_add_f32 v140, v140, v44
    v_add_f32 v141, v141, v45
    v_add_f32 v142, v142, v46
    v_add_f32 v143, v143, v47
    v_add_f32 v144, v144, v48
    v_add_f32 v145, v145, v49
    v_add_f32 v146, v146, v50
    v_add_f32 v147, v147, v51
    v_fmac_f32 v68, v132, v52
    v_fmac_f32 v69, v133, v53
    v_fmac_f32 v70, v134, v54
    v_fmac_f32 v71, v135, v55
    v_fmac_f32 v72, v136, v56
    v_fmac_f32 v73, v137, v57
    v_fmac_f32 v74, v138, v58
    v_fmac_f32 v75, v139, v59
    v_fmac_f32 v76, v140, v60
    v_fmac_f32 v77, v141, v61
    v_fmac_f32 v78, v142, v62
    v_fmac_f32 v79, v143, v63
    v_fmac_f32 v80, v144, v64
    v_fmac_f32 v81, v145, v65
    v_fmac_f32 v82, v146, v66
    v_fmac_f32 v83, v147, v67
    v_cvt_pk_bf16_f32 v4, v68, v69
    v_cvt_pk_bf16_f32 v5, v70, v71
    v_cvt_pk_bf16_f32 v6, v72, v73
    v_cvt_pk_bf16_f32 v7, v74, v75
    v_cvt_pk_bf16_f32 v8, v76, v77
    v_cvt_pk_bf16_f32 v9, v78, v79
    v_cvt_pk_bf16_f32 v10, v80, v81
    v_cvt_pk_bf16_f32 v11, v82, v83
    s_nop 1
    v_permlane32_swap_b32 v4, v6
    v_permlane32_swap_b32 v5, v7
    v_permlane32_swap_b32 v8, v10
    v_permlane32_swap_b32 v9, v11
    s_nop 1
    buffer_store_dwordx4 v[4:7], v164, s[40:43], s94 offen offset:0
    buffer_store_dwordx4 v[8:11], v164, s[40:43], s94 offen offset:32
    s_endpgm
K2_C0:
    ds_write_b128 v3, v[100:103] offset:20480
    ds_write_b128 v3, v[104:107] offset:21504
    ds_write_b128 v3, v[108:111] offset:22528
    ds_write_b128 v3, v[112:115] offset:23552
    ds_write_b128 v3, v[116:119] offset:28672
    ds_write_b128 v3, v[120:123] offset:29696
    ds_write_b128 v3, v[124:127] offset:30720
    ds_write_b128 v3, v[128:131] offset:31744
    ds_write_b128 v3, v[132:135] offset:36864
    ds_write_b128 v3, v[136:139] offset:37888
    ds_write_b128 v3, v[140:143] offset:38912
    ds_write_b128 v3, v[144:147] offset:39936
    s_waitcnt lgkmcnt(0)
    s_barrier
    ds_read_b128 v[4:7], v3 offset:0
    ds_read_b128 v[8:11], v3 offset:1024
    ds_read_b128 v[12:15], v3 offset:2048
    ds_read_b128 v[16:19], v3 offset:3072
    ds_read_b128 v[20:23], v3 offset:4096
    ds_read_b128 v[24:27], v3 offset:5120
    ds_read_b128 v[28:31], v3 offset:6144
    ds_read_b128 v[32:35], v3 offset:7168
    ds_read_b128 v[36:39], v3 offset:8192
    ds_read_b128 v[40:43], v3 offset:9216
    ds_read_b128 v[44:47], v3 offset:10240
    ds_read_b128 v[48:51], v3 offset:11264
    v_lshlrev_b32 v52, 16, v148
    v_and_b32 v53, 0xffff0000, v148
    v_lshlrev_b32 v54, 16, v149
    v_and_b32 v55, 0xffff0000, v149
    v_lshlrev_b32 v56, 16, v150
    v_and_b32 v57, 0xffff0000, v150
    v_lshlrev_b32 v58, 16, v151
    v_and_b32 v59, 0xffff0000, v151
    v_lshlrev_b32 v60, 16, v152
    v_and_b32 v61, 0xffff0000, v152
    v_lshlrev_b32 v62, 16, v153
    v_and_b32 v63, 0xffff0000, v153
    v_lshlrev_b32 v64, 16, v154
    v_and_b32 v65, 0xffff0000, v154
    v_lshlrev_b32 v66, 16, v155
    v_and_b32 v67, 0xffff0000, v155
    v_lshlrev_b32 v68, 16, v156
    v_and_b32 v69, 0xffff0000, v156
    v_lshlrev_b32 v70, 16, v157
    v_and_b32 v71, 0xffff0000, v157
    v_lshlrev_b32 v72, 16, v158
    v_and_b32 v73, 0xffff0000, v158
    v_lshlrev_b32 v74, 16, v159
    v_and_b32 v75, 0xffff0000, v159
    v_lshlrev_b32 v76, 16, v160
    v_and_b32 v77, 0xffff0000, v160
    v_lshlrev_b32 v78, 16, v161
    v_and_b32 v79, 0xffff0000, v161
    v_lshlrev_b32 v80, 16, v162
    v_and_b32 v81, 0xffff0000, v162
    v_lshlrev_b32 v82, 16, v163
    v_and_b32 v83, 0xffff0000, v163
    s_waitcnt lgkmcnt(8)
    v_add_f32 v84, v84, v4
    v_add_f32 v85, v85, v5
    v_add_f32 v86, v86, v6
    v_add_f32 v87, v87, v7
    v_add_f32 v88, v88, v8
    v_add_f32 v89, v89, v9
    v_add_f32 v90, v90, v10
    v_add_f32 v91, v91, v11
    v_add_f32 v92, v92, v12
    v_add_f32 v93, v93, v13
    v_add_f32 v94, v94, v14
    v_add_f32 v95, v95, v15
    v_add_f32 v96, v96, v16
    v_add_f32 v97, v97, v17
    v_add_f32 v98, v98, v18
    v_add_f32 v99, v99, v19
    s_waitcnt lgkmcnt(4)
    v_add_f32 v84, v84, v20
    v_add_f32 v85, v85, v21
    v_add_f32 v86, v86, v22
    v_add_f32 v87, v87, v23
    v_add_f32 v88, v88, v24
    v_add_f32 v89, v89, v25
    v_add_f32 v90, v90, v26
    v_add_f32 v91, v91, v27
    v_add_f32 v92, v92, v28
    v_add_f32 v93, v93, v29
    v_add_f32 v94, v94, v30
    v_add_f32 v95, v95, v31
    v_add_f32 v96, v96, v32
    v_add_f32 v97, v97, v33
    v_add_f32 v98, v98, v34
    v_add_f32 v99, v99, v35
    s_waitcnt lgkmcnt(0)
    v_add_f32 v84, v84, v36
    v_add_f32 v85, v85, v37
    v_add_f32 v86, v86, v38
    v_add_f32 v87, v87, v39
    v_add_f32 v88, v88, v40
    v_add_f32 v89, v89, v41
    v_add_f32 v90, v90, v42
    v_add_f32 v91, v91, v43
    v_add_f32 v92, v92, v44
    v_add_f32 v93, v93, v45
    v_add_f32 v94, v94, v46
    v_add_f32 v95, v95, v47
    v_add_f32 v96, v96, v48
    v_add_f32 v97, v97, v49
    v_add_f32 v98, v98, v50
    v_add_f32 v99, v99, v51
    v_fmac_f32 v68, v84, v52
    v_fmac_f32 v69, v85, v53
    v_fmac_f32 v70, v86, v54
    v_fmac_f32 v71, v87, v55
    v_fmac_f32 v72, v88, v56
    v_fmac_f32 v73, v89, v57
    v_fmac_f32 v74, v90, v58
    v_fmac_f32 v75, v91, v59
    v_fmac_f32 v76, v92, v60
    v_fmac_f32 v77, v93, v61
    v_fmac_f32 v78, v94, v62
    v_fmac_f32 v79, v95, v63
    v_fmac_f32 v80, v96, v64
    v_fmac_f32 v81, v97, v65
    v_fmac_f32 v82, v98, v66
    v_fmac_f32 v83, v99, v67
    v_cvt_pk_bf16_f32 v4, v68, v69
    v_cvt_pk_bf16_f32 v5, v70, v71
    v_cvt_pk_bf16_f32 v6, v72, v73
    v_cvt_pk_bf16_f32 v7, v74, v75
    v_cvt_pk_bf16_f32 v8, v76, v77
    v_cvt_pk_bf16_f32 v9, v78, v79
    v_cvt_pk_bf16_f32 v10, v80, v81
    v_cvt_pk_bf16_f32 v11, v82, v83
    s_nop 1
    v_permlane32_swap_b32 v4, v6
    v_permlane32_swap_b32 v5, v7
    v_permlane32_swap_b32 v8, v10
    v_permlane32_swap_b32 v9, v11
    s_nop 1
    buffer_store_dwordx4 v[4:7], v164, s[40:43], s94 offen offset:0
    buffer_store_dwordx4 v[8:11], v164, s[40:43], s94 offen offset:32
    s_endpgm
K2_C1:
    ds_write_b128 v3, v[84:87] offset:0
    ds_write_b128 v3, v[88:91] offset:1024
    ds_write_b128 v3, v[92:95] offset:2048
    ds_write_b128 v3, v[96:99] offset:3072
    ds_write_b128 v3, v[116:119] offset:32768
    ds_write_b128 v3, v[120:123] offset:33792
    ds_write_b128 v3, v[124:127] offset:34816
    ds_write_b128 v3, v[128:131] offset:35840
    ds_write_b128 v3, v[132:135] offset:40960
    ds_write_b128 v3, v[136:139] offset:41984
    ds_write_b128 v3, v[140:143] offset:43008
    ds_write_b128 v3, v[144:147] offset:44032
    s_waitcnt lgkmcnt(0)
    s_barrier
    ds_read_b128 v[4:7], v3 offset:12288
    ds_read_b128 v[8:11], v3 offset:13312
    ds_read_b128 v[12:15], v3 offset:14336
    ds_read_b128 v[16:19], v3 offset:15360
    ds_read_b128 v[20:23], v3 offset:16384
    ds_read_b128 v[24:27], v3 offset:17408
    ds_read_b128 v[28:31], v3 offset:18432
    ds_read_b128 v[32:35], v3 offset:19456
    ds_read_b128 v[36:39], v3 offset:20480
    ds_read_b128 v[40:43], v3 offset:21504
    ds_read_b128 v[44:47], v3 offset:22528
    ds_read_b128 v[48:51], v3 offset:23552
    v_lshlrev_b32 v52, 16, v148
    v_and_b32 v53, 0xffff0000, v148
    v_lshlrev_b32 v54, 16, v149
    v_and_b32 v55, 0xffff0000, v149
    v_lshlrev_b32 v56, 16, v150
    v_and_b32 v57, 0xffff0000, v150
    v_lshlrev_b32 v58, 16, v151
    v_and_b32 v59, 0xffff0000, v151
    v_lshlrev_b32 v60, 16, v152
    v_and_b32 v61, 0xffff0000, v152
    v_lshlrev_b32 v62, 16, v153
    v_and_b32 v63, 0xffff0000, v153
    v_lshlrev_b32 v64, 16, v154
    v_and_b32 v65, 0xffff0000, v154
    v_lshlrev_b32 v66, 16, v155
    v_and_b32 v67, 0xffff0000, v155
    v_lshlrev_b32 v68, 16, v156
    v_and_b32 v69, 0xffff0000, v156
    v_lshlrev_b32 v70, 16, v157
    v_and_b32 v71, 0xffff0000, v157
    v_lshlrev_b32 v72, 16, v158
    v_and_b32 v73, 0xffff0000, v158
    v_lshlrev_b32 v74, 16, v159
    v_and_b32 v75, 0xffff0000, v159
    v_lshlrev_b32 v76, 16, v160
    v_and_b32 v77, 0xffff0000, v160
    v_lshlrev_b32 v78, 16, v161
    v_and_b32 v79, 0xffff0000, v161
    v_lshlrev_b32 v80, 16, v162
    v_and_b32 v81, 0xffff0000, v162
    v_lshlrev_b32 v82, 16, v163
    v_and_b32 v83, 0xffff0000, v163
    s_waitcnt lgkmcnt(8)
    v_add_f32 v100, v100, v4
    v_add_f32 v101, v101, v5
    v_add_f32 v102, v102, v6
    v_add_f32 v103, v103, v7
    v_add_f32 v104, v104, v8
    v_add_f32 v105, v105, v9
    v_add_f32 v106, v106, v10
    v_add_f32 v107, v107, v11
    v_add_f32 v108, v108, v12
    v_add_f32 v109, v109, v13
    v_add_f32 v110, v110, v14
    v_add_f32 v111, v111, v15
    v_add_f32 v112, v112, v16
    v_add_f32 v113, v113, v17
    v_add_f32 v114, v114, v18
    v_add_f32 v115, v115, v19
    s_waitcnt lgkmcnt(4)
    v_add_f32 v100, v100, v20
    v_add_f32 v101, v101, v21
    v_add_f32 v102, v102, v22
    v_add_f32 v103, v103, v23
    v_add_f32 v104, v104, v24
    v_add_f32 v105, v105, v25
    v_add_f32 v106, v106, v26
    v_add_f32 v107, v107, v27
    v_add_f32 v108, v108, v28
    v_add_f32 v109, v109, v29
    v_add_f32 v110, v110, v30
    v_add_f32 v111, v111, v31
    v_add_f32 v112, v112, v32
    v_add_f32 v113, v113, v33
    v_add_f32 v114, v114, v34
    v_add_f32 v115, v115, v35
    s_waitcnt lgkmcnt(0)
    v_add_f32 v100, v100, v36
    v_add_f32 v101, v101, v37
    v_add_f32 v102, v102, v38
    v_add_f32 v103, v103, v39
    v_add_f32 v104, v104, v40
    v_add_f32 v105, v105, v41
    v_add_f32 v106, v106, v42
    v_add_f32 v107, v107, v43
    v_add_f32 v108, v108, v44
    v_add_f32 v109, v109, v45
    v_add_f32 v110, v110, v46
    v_add_f32 v111, v111, v47
    v_add_f32 v112, v112, v48
    v_add_f32 v113, v113, v49
    v_add_f32 v114, v114, v50
    v_add_f32 v115, v115, v51
    v_fmac_f32 v68, v100, v52
    v_fmac_f32 v69, v101, v53
    v_fmac_f32 v70, v102, v54
    v_fmac_f32 v71, v103, v55
    v_fmac_f32 v72, v104, v56
    v_fmac_f32 v73, v105, v57
    v_fmac_f32 v74, v106, v58
    v_fmac_f32 v75, v107, v59
    v_fmac_f32 v76, v108, v60
    v_fmac_f32 v77, v109, v61
    v_fmac_f32 v78, v110, v62
    v_fmac_f32 v79, v111, v63
    v_fmac_f32 v80, v112, v64
    v_fmac_f32 v81, v113, v65
    v_fmac_f32 v82, v114, v66
    v_fmac_f32 v83, v115, v67
    v_cvt_pk_bf16_f32 v4, v68, v69
    v_cvt_pk_bf16_f32 v5, v70, v71
    v_cvt_pk_bf16_f32 v6, v72, v73
    v_cvt_pk_bf16_f32 v7, v74, v75
    v_cvt_pk_bf16_f32 v8, v76, v77
    v_cvt_pk_bf16_f32 v9, v78, v79
    v_cvt_pk_bf16_f32 v10, v80, v81
    v_cvt_pk_bf16_f32 v11, v82, v83
    s_nop 1
    v_permlane32_swap_b32 v4, v6
    v_permlane32_swap_b32 v5, v7
    v_permlane32_swap_b32 v8, v10
    v_permlane32_swap_b32 v9, v11
    s_nop 1
    buffer_store_dwordx4 v[4:7], v164, s[40:43], s94 offen offset:0
    buffer_store_dwordx4 v[8:11], v164, s[40:43], s94 offen offset:32
    s_endpgm
K2_C2:
    ds_write_b128 v3, v[84:87] offset:4096
    ds_write_b128 v3, v[88:91] offset:5120
    ds_write_b128 v3, v[92:95] offset:6144
    ds_write_b128 v3, v[96:99] offset:7168
    ds_write_b128 v3, v[100:103] offset:12288
    ds_write_b128 v3, v[104:107] offset:13312
    ds_write_b128 v3, v[108:111] offset:14336
    ds_write_b128 v3, v[112:115] offset:15360
    ds_write_b128 v3, v[132:135] offset:45056
    ds_write_b128 v3, v[136:139] offset:46080
    ds_write_b128 v3, v[140:143] offset:47104
    ds_write_b128 v3, v[144:147] offset:48128
    s_waitcnt lgkmcnt(0)
    s_barrier
    ds_read_b128 v[4:7], v3 offset:24576
    ds_read_b128 v[8:11], v3 offset:25600
    ds_read_b128 v[12:15], v3 offset:26624
    ds_read_b128 v[16:19], v3 offset:27648
    ds_read_b128 v[20:23], v3 offset:28672
    ds_read_b128 v[24:27], v3 offset:29696
    ds_read_b128 v[28:31], v3 offset:30720
    ds_read_b128 v[32:35], v3 offset:31744
    ds_read_b128 v[36:39], v3 offset:32768
    ds_read_b128 v[40:43], v3 offset:33792
    ds_read_b128 v[44:47], v3 offset:34816
    ds_read_b128 v[48:51], v3 offset:35840
    v_lshlrev_b32 v52, 16, v148
    v_and_b32 v53, 0xffff0000, v148
    v_lshlrev_b32 v54, 16, v149
    v_and_b32 v55, 0xffff0000, v149
    v_lshlrev_b32 v56, 16, v150
    v_and_b32 v57, 0xffff0000, v150
    v_lshlrev_b32 v58, 16, v151
    v_and_b32 v59, 0xffff0000, v151
    v_lshlrev_b32 v60, 16, v152
    v_and_b32 v61, 0xffff0000, v152
    v_lshlrev_b32 v62, 16, v153
    v_and_b32 v63, 0xffff0000, v153
    v_lshlrev_b32 v64, 16, v154
    v_and_b32 v65, 0xffff0000, v154
    v_lshlrev_b32 v66, 16, v155
    v_and_b32 v67, 0xffff0000, v155
    v_lshlrev_b32 v68, 16, v156
    v_and_b32 v69, 0xffff0000, v156
    v_lshlrev_b32 v70, 16, v157
    v_and_b32 v71, 0xffff0000, v157
    v_lshlrev_b32 v72, 16, v158
    v_and_b32 v73, 0xffff0000, v158
    v_lshlrev_b32 v74, 16, v159
    v_and_b32 v75, 0xffff0000, v159
    v_lshlrev_b32 v76, 16, v160
    v_and_b32 v77, 0xffff0000, v160
    v_lshlrev_b32 v78, 16, v161
    v_and_b32 v79, 0xffff0000, v161
    v_lshlrev_b32 v80, 16, v162
    v_and_b32 v81, 0xffff0000, v162
    v_lshlrev_b32 v82, 16, v163
    v_and_b32 v83, 0xffff0000, v163
    s_waitcnt lgkmcnt(8)
    v_add_f32 v116, v116, v4
    v_add_f32 v117, v117, v5
    v_add_f32 v118, v118, v6
    v_add_f32 v119, v119, v7
    v_add_f32 v120, v120, v8
    v_add_f32 v121, v121, v9
    v_add_f32 v122, v122, v10
    v_add_f32 v123, v123, v11
    v_add_f32 v124, v124, v12
    v_add_f32 v125, v125, v13
    v_add_f32 v126, v126, v14
    v_add_f32 v127, v127, v15
    v_add_f32 v128, v128, v16
    v_add_f32 v129, v129, v17
    v_add_f32 v130, v130, v18
    v_add_f32 v131, v131, v19
    s_waitcnt lgkmcnt(4)
    v_add_f32 v116, v116, v20
    v_add_f32 v117, v117, v21
    v_add_f32 v118, v118, v22
    v_add_f32 v119, v119, v23
    v_add_f32 v120, v120, v24
    v_add_f32 v121, v121, v25
    v_add_f32 v122, v122, v26
    v_add_f32 v123, v123, v27
    v_add_f32 v124, v124, v28
    v_add_f32 v125, v125, v29
    v_add_f32 v126, v126, v30
    v_add_f32 v127, v127, v31
    v_add_f32 v128, v128, v32
    v_add_f32 v129, v129, v33
    v_add_f32 v130, v130, v34
    v_add_f32 v131, v131, v35
    s_waitcnt lgkmcnt(0)
    v_add_f32 v116, v116, v36
    v_add_f32 v117, v117, v37
    v_add_f32 v118, v118, v38
    v_add_f32 v119, v119, v39
    v_add_f32 v120, v120, v40
    v_add_f32 v121, v121, v41
    v_add_f32 v122, v122, v42
    v_add_f32 v123, v123, v43
    v_add_f32 v124, v124, v44
    v_add_f32 v125, v125, v45
    v_add_f32 v126, v126, v46
    v_add_f32 v127, v127, v47
    v_add_f32 v128, v128, v48
    v_add_f32 v129, v129, v49
    v_add_f32 v130, v130, v50
    v_add_f32 v131, v131, v51
    v_fmac_f32 v68, v116, v52
    v_fmac_f32 v69, v117, v53
    v_fmac_f32 v70, v118, v54
    v_fmac_f32 v71, v119, v55
    v_fmac_f32 v72, v120, v56
    v_fmac_f32 v73, v121, v57
    v_fmac_f32 v74, v122, v58
    v_fmac_f32 v75, v123, v59
    v_fmac_f32 v76, v124, v60
    v_fmac_f32 v77, v125, v61
    v_fmac_f32 v78, v126, v62
    v_fmac_f32 v79, v127, v63
    v_fmac_f32 v80, v128, v64
    v_fmac_f32 v81, v129, v65
    v_fmac_f32 v82, v130, v66
    v_fmac_f32 v83, v131, v67
    v_cvt_pk_bf16_f32 v4, v68, v69
    v_cvt_pk_bf16_f32 v5, v70, v71
    v_cvt_pk_bf16_f32 v6, v72, v73
    v_cvt_pk_bf16_f32 v7, v74, v75
    v_cvt_pk_bf16_f32 v8, v76, v77
    v_cvt_pk_bf16_f32 v9, v78, v79
    v_cvt_pk_bf16_f32 v10, v80, v81
    v_cvt_pk_bf16_f32 v11, v82, v83
    s_nop 1
    v_permlane32_swap_b32 v4, v6
    v_permlane32_swap_b32 v5, v7
    v_permlane32_swap_b32 v8, v10
    v_permlane32_swap_b32 v9, v11
    s_nop 1
    buffer_store_dwordx4 v[4:7], v164, s[40:43], s94 offen offset:0
    buffer_store_dwordx4 v[8:11], v164, s[40:43], s94 offen offset:32
    s_endpgm
FZ_END:
    s_endpgm
.section .rodata,"a"
.p2align 6
.amdhsa_kernel recurrent_scan__softmax_full_mha__mixer_channel_mlp__prompt_kernel
  .amdhsa_next_free_vgpr 168
  .amdhsa_next_free_sgpr 102
  .amdhsa_accum_offset 168
  .amdhsa_group_segment_fixed_size 0
  .amdhsa_kernarg_size 88
  .amdhsa_user_sgpr_count 2
  .amdhsa_user_sgpr_kernarg_segment_ptr 1
  .amdhsa_system_sgpr_workgroup_id_x 1
  .amdhsa_float_denorm_mode_32 3
.end_amdhsa_kernel
```
